```python
import torch

def _softmax(x, axis=-1):
    return torch.softmax(x, dim=axis)
def _gelu(x):
    return torch.nn.functional.gelu(x, approximate="tanh")
def _silu(x):
    return torch.nn.functional.silu(x)
def _sigmoid(x):
    return torch.sigmoid(x)
def _layernorm(x, axis=-1, eps=1e-5):
    m = x.mean(dim=axis, keepdim=True)
    v = x.var(dim=axis, keepdim=True, unbiased=False)
    return (x - m) / torch.sqrt(v + eps)
def _scatter_add(tgt, idx, src, axis=0):
    return tgt.clone().index_add_(axis, idx, src)
def _segment_sum(src, seg, n):
    out = torch.zeros((n,) + src.shape[1:], dtype=src.dtype)
    return out.index_add_(0, seg, src)
def _pad(x, pw):
    flat = tuple(v for pair in reversed(pw) for v in pair)
    return torch.nn.functional.pad(x, flat)

kernel_name = 'concat_heads__ssm_conv_s5__ssm_conv_s4__prompt'

def setup_inputs():

    _w = (lambda a: (lambda t: t.to(torch.bfloat16) if t.is_floating_point() else t)(torch.as_tensor(a)))
    def _A_setup():
        B, S, D = 1, 2048, 512
        P = D
        Lambda_re = -0.5 * (lambda _x: torch.exp(torch.as_tensor(_x)))((lambda *s: torch.randn(*s, dtype=torch.bfloat16) * 0.2)(P))
        Lambda_im = (lambda *s: torch.randn(*s, dtype=torch.bfloat16) * 0.4)(P) * 1.0
        B_re = (lambda *s: torch.randn(*s, dtype=torch.bfloat16) * 0.2)(P, D) * (D ** -0.5)
        B_im = (lambda *s: torch.randn(*s, dtype=torch.bfloat16) * 0.2)(P, D) * (D ** -0.5)
        C_re = (lambda *s: torch.randn(*s, dtype=torch.bfloat16) * 0.2)(D, P) * (P ** -0.5)
        C_im = (lambda *s: torch.randn(*s, dtype=torch.bfloat16) * 0.2)(D, P) * (P ** -0.5)
        log_dt = (lambda *s: torch.randn(*s, dtype=torch.bfloat16) * 0.2)(P) * 0.3 - 2.0
        Dskip = (lambda *s: torch.randn(*s, dtype=torch.bfloat16) * 0.05)(D)
        return {
            "x": _w((lambda *s: torch.randn(*s, dtype=torch.bfloat16) * 0.05)(B, S, D)),
            "Lambda_re": _w(Lambda_re),
            "Lambda_im": _w(Lambda_im),
            "B_re": _w(B_re),
            "B_im": _w(B_im),
            "C_re": _w(C_re),
            "C_im": _w(C_im),
            "log_dt": _w(log_dt),
            "Dskip": _w(Dskip),
        }
    _A_in = _A_setup()

    def _B_setup():
        B, L, D, N = 1, 2048, 512, 128
        A_re = -(lambda _x: torch.exp(torch.as_tensor(_x)))((lambda *s: torch.randn(*s, dtype=torch.bfloat16) * 3.2)(D, N))
        A_im = torch.pi * (lambda *s: torch.randn(*s, dtype=torch.bfloat16) * 0.05)(D, N)
        B_re = (lambda *s: torch.randn(*s, dtype=torch.bfloat16) * 0.1)(D, N)
        B_im = (lambda *s: torch.randn(*s, dtype=torch.bfloat16) * 0.1)(D, N)
        C_re = (lambda *s: torch.randn(*s, dtype=torch.bfloat16) * 0.1)(D, N)
        C_im = (lambda *s: torch.randn(*s, dtype=torch.bfloat16) * 0.1)(D, N)
        log_dt = (lambda *s: torch.randn(*s, dtype=torch.bfloat16) * 0.05)(D) * 0.5 - 4.0
        Dskip = (lambda *s: torch.randn(*s, dtype=torch.bfloat16) * 0.05)(D)
        return {
            "u": _w((lambda *s: torch.randn(*s, dtype=torch.bfloat16) * 0.05)(B, L, D)),
            "A_re": _w(A_re),
            "A_im": _w(A_im),
            "B_re": _w(B_re),
            "B_im": _w(B_im),
            "C_re": _w(C_re),
            "C_im": _w(C_im),
            "log_dt": _w(log_dt),
            "Dskip": _w(Dskip),
        }
    _B_in = _B_setup()

    return {
        "A_x": _A_in["x"],
        "A_Lambda_re": _A_in["Lambda_re"],
        "A_Lambda_im": _A_in["Lambda_im"],
        "A_B_re": _A_in["B_re"],
        "A_B_im": _A_in["B_im"],
        "A_C_re": _A_in["C_re"],
        "A_C_im": _A_in["C_im"],
        "A_log_dt": _A_in["log_dt"],
        "A_Dskip": _A_in["Dskip"],
        "B_u": _B_in["u"],
        "B_A_re": _B_in["A_re"],
        "B_A_im": _B_in["A_im"],
        "B_B_re": _B_in["B_re"],
        "B_B_im": _B_in["B_im"],
        "B_C_re": _B_in["C_re"],
        "B_C_im": _B_in["C_im"],
        "B_log_dt": _B_in["log_dt"],
        "B_Dskip": _B_in["Dskip"],
    }

def reference(A_x, A_Lambda_re, A_Lambda_im, A_B_re, A_B_im, A_C_re, A_C_im, A_log_dt, A_Dskip, B_u, B_A_re, B_A_im, B_B_re, B_B_im, B_C_re, B_C_im, B_log_dt, B_Dskip):
    def _A_ref(x, Lambda_re, Lambda_im, B_re, B_im, C_re, C_im, log_dt, Dskip):
        Bsz, L, H = x.shape
        Lam = Lambda_re + 1j * Lambda_im
        Bmat = B_re + 1j * B_im
        Cmat = C_re + 1j * C_im
        dt = torch.exp(log_dt)
        Lam_bar = torch.exp(dt * Lam)
        B_bar = ((Lam_bar - 1.0) / Lam)[:, None] * Bmat
        Bu = torch.einsum("bld,pd->blp", x + 0j, B_bar)
        h = torch.zeros_like(Bu[:, 0, :])
        hs = []
        for t in range(L):
            h = Lam_bar[None, :] * h + Bu[:, t, :]
            hs.append(h)
        hseq = torch.stack(hs, 1)
        y = 2.0 * torch.einsum("blp,dp->bld", hseq, Cmat).real + x * Dskip[None, None, :]
        return y

    def _B_ref(u, A_re, A_im, B_re, B_im, C_re, C_im, log_dt, Dskip):
        Bsz, L, D = u.shape
        dt = torch.exp(log_dt)[:, None]
        A = A_re + 1j * A_im
        Bc = B_re + 1j * B_im
        Cc = C_re + 1j * C_im
        logdA = dt * A
        dB = dt * Bc
        l = (lambda x, dt: x.to(dt))(torch.arange(L), A_re.dtype)
        P = torch.exp(logdA[:, :, None] * l[None, None, :])
        K = torch.einsum("dn,dnl,dn->dl", Cc, P, dB).real
        L2 = 2 * L
        Kp = _pad(K, ((0, 0), (0, L)))
        up = (lambda x, *d: x.permute(*d))(u, 0, 2, 1)
        up = _pad(up, ((0, 0), (0, 0), (0, L)))
        Kf = (lambda x, axes=(-2,-1): torch.fft.rfft2(x.float(), dim=axes))(Kp[:, None, :], axes=(-2, -1))
        Uf = (lambda x, axes=(-2,-1): torch.fft.rfft2(x.float(), dim=axes))(up[:, :, None, :], axes=(-2, -1))
        Yf = Uf * Kf[None, :, :, :]
        y = (lambda x, s, axes=(-2,-1): torch.fft.irfft2(x, s=s, dim=axes).to(torch.bfloat16))(Yf, (1, L2), axes=(-2, -1))[:, :, 0, :L]
        y = (lambda x, *d: x.permute(*d))(y, 0, 2, 1) + u * Dskip[None, None, :]
        return y

    a = _A_ref(A_x, A_Lambda_re, A_Lambda_im, A_B_re, A_B_im, A_C_re, A_C_im, A_log_dt, A_Dskip)
    b = _B_ref(B_u, B_A_re, B_A_im, B_B_re, B_B_im, B_C_re, B_C_im, B_log_dt, B_Dskip)
    return torch.concatenate([a, b], axis=-1)
```

```asm
; @launch grid=(256,1,1) block=(512,1,1) lds=163840
.amdgcn_target "amdgcn-amd-amdhsa--gfx950"
.text
.globl concat_heads__ssm_conv_s5__ssm_conv_s4__prompt_kernel
.p2align 8
.type concat_heads__ssm_conv_s5__ssm_conv_s4__prompt_kernel,@function
concat_heads__ssm_conv_s5__ssm_conv_s4__prompt_kernel:
s_cmp_ge_u32 s2, 256
s_cbranch_scc1 L_end
s_load_dwordx8 s[40:47], s[0:1], 128
s_load_dwordx2 s[48:49], s[0:1], 160
s_load_dwordx16 s[8:23], s[0:1], 0
s_load_dwordx16 s[24:39], s[0:1], 64
v_and_b32 v0, 0x3ff, v0
v_and_b32 v1, 63, v0
v_lshrrev_b32 v6, 6, v0
v_and_b32 v2, 15, v0
v_readfirstlane_b32 s3, v6
v_bfe_u32 v3, v0, 4, 2
v_mov_b32 v4, 141824
v_mov_b32 v5, 1
s_and_b32 s4, s2, 7
s_bfe_u32 s5, s2, 0x40003
s_cmp_ge_u32 s2, 128
s_cbranch_scc1 L_roleB
s_cmp_ge_u32 s3, 4
s_cbranch_scc1 L_A_nopar
s_and_b32 s7, s4, 1
s_lshl_b32 s7, s7, 2
s_and_b32 s50, s5, 3
s_add_u32 s7, s7, s50
s_lshl_b32 s76, s7, 7
v_lshl_add_u32 v52, v1, 1, s76
s_waitcnt lgkmcnt(0)
global_load_ushort v53, v52, s[10:11]
global_load_ushort v54, v52, s[12:13]
global_load_ushort v55, v52, s[22:23]
L_A_nopar:
s_lshr_b32 s6, s4, 1
s_lshl_b32 s6, s6, 2
s_lshr_b32 s51, s5, 2
s_add_u32 s6, s6, s51
s_lshl_b32 s51, s51, 1
s_and_b32 s7, s4, 1
s_lshl_b32 s7, s7, 2
s_and_b32 s50, s5, 3
s_add_u32 s7, s7, s50
s_add_u32 s50, s7, s51
s_sub_u32 s51, 8, s51
s_and_b32 s51, s51, 7
s_mov_b32 s82, s6
s_mov_b32 s83, s7
s_and_b32 s81, s3, 3
v_lshrrev_b32 v48, 3, v1
v_and_b32 v49, 7, v1
v_bfe_u32 v50, v1, 4, 1
v_or_b32 v51, 0, v50
v_xor_b32 v51, v51, v49
v_lshlrev_b32 v51, 4, v51
v_lshl_add_u32 v144, v48, 10, v51
v_add_u32 v144, 0, v144
v_or_b32 v51, 2, v50
v_xor_b32 v51, v51, v49
v_lshlrev_b32 v51, 4, v51
v_lshl_add_u32 v145, v48, 10, v51
v_add_u32 v145, 7168, v145
v_or_b32 v51, 4, v50
v_xor_b32 v51, v51, v49
v_lshlrev_b32 v51, 4, v51
v_lshl_add_u32 v146, v48, 10, v51
v_add_u32 v146, 14336, v146
v_or_b32 v51, 6, v50
v_xor_b32 v51, v51, v49
v_lshlrev_b32 v51, 4, v51
v_lshl_add_u32 v147, v48, 10, v51
v_add_u32 v147, 21504, v147
v_and_b32 v50, 3, v48
v_lshlrev_b32 v50, 13, v50
v_lshrrev_b32 v48, 5, v1
v_lshl_add_u32 v48, v48, 11, v50
v_or_b32 v51, 0, v3
v_xor_b32 v51, v51, v49
v_lshl_add_u32 v148, v51, 4, v48
v_add_u32 v148, 0, v148
v_or_b32 v51, 4, v3
v_xor_b32 v51, v51, v49
v_lshl_add_u32 v149, v51, 4, v48
v_add_u32 v149, 3072, v149
s_lshl_b32 s78, s6, 17
s_lshl_b32 s76, s81, 15
s_add_u32 s78, s78, s76
s_lshl_b32 s79, s7, 16
s_and_b32 s76, s3, 1
s_lshl_b32 s76, s76, 10
s_add_u32 s79, s79, s76
s_lshl_b32 s80, s81, 12
s_lshl_b32 s75, s81, 11
s_bfe_u32 s77, s3, 0x10001
s_lshl_b32 s7, s7, 1
s_add_u32 s7, s7, s77
s_lshl_b32 s76, s83, 7
v_lshl_add_u32 v115, v3, 3, s76
v_lshrrev_b32 v48, 1, v2
v_xor_b32 v48, v48, v3
v_lshlrev_b32 v48, 4, v48
v_lshrrev_b32 v49, 2, v2
v_lshlrev_b32 v49, 3, v49
v_and_b32 v50, 3, v2
v_add_u32 v49, v49, v50
v_lshl_add_u32 v12, v49, 7, v48
s_and_b32 s76, s3, 1
s_lshl_b32 s76, s76, 13
v_add_u32 v12, s76, v12
v_xor_b32 v13, 64, v12
v_lshl_add_u32 v14, v2, 7, v48
s_lshl_b32 s76, s77, 13
s_add_u32 s76, s76, 16384
v_add_u32 v14, s76, v14
v_xor_b32 v15, 64, v14
v_add_u32 v124, 0x10000, v12
v_add_u32 v125, 0x10000, v13
v_add_u32 v126, 0x10000, v14
v_add_u32 v127, 0x10000, v15
s_waitcnt lgkmcnt(0)
s_and_b32 s34, s3, 1
s_lshl_b32 s34, s34, 1
s_lshr_b32 s35, s3, 2
s_add_u32 s34, s34, s35
s_mov_b32 s35, s77
s_lshl_b32 s39, s34, 1
s_add_u32 s39, s39, s35
s_mov_b32 s52, s8
s_and_b32 s53, s9, 0xffff
s_mov_b32 s54, 2097152
s_mov_b32 s55, 0x00020000
s_bitcmp1_b32 s3, 1
s_cselect_b32 s56, s16, s14
s_cselect_b32 s57, s17, s15
s_and_b32 s57, s57, 0xffff
s_mov_b32 s58, 0x80000
s_mov_b32 s59, 0x00020000
s_mov_b32 s68, s48
s_and_b32 s69, s49, 0xffff
s_mov_b32 s70, 16777216
s_mov_b32 s71, 0x00020000
s_mov_b32 s60, s18
s_and_b32 s61, s19, 0xffff
s_mov_b32 s64, s20
s_and_b32 s65, s21, 0xffff
s_mov_b32 s62, 0x80000
s_mov_b32 s63, 0x00020000
s_mov_b32 s66, 0x80000
s_mov_b32 s67, 0x00020000
s_and_b32 s76, s81, 1
s_lshl_b32 s76, s76, 7
v_lshlrev_b32 v8, 4, v1
v_xor_b32 v8, s76, v8
s_lshl_b32 s36, s83, 7
s_lshl_b32 s37, s81, 13
s_lshl_b32 s38, s83, 16
s_add_u32 s38, s38, s37
s_cmp_lt_u32 s3, 4
s_cbranch_scc1 L_A_comp
s_add_u32 s76, s50, 0
s_and_b32 s76, s76, 7
s_lshl_b32 s76, s76, 7
s_add_u32 m0, s80, 0
s_add_u32 s77, s76, s78
s_add_u32 s76, s76, s79
buffer_load_dwordx4 v144, s[52:55], s77 offen offset:0 lds
buffer_load_dwordx4 v145, s[52:55], s77 offen offset:1024 lds
buffer_load_dwordx4 v146, s[52:55], s77 offen offset:2048 lds
buffer_load_dwordx4 v147, s[52:55], s77 offen offset:3072 lds
s_add_u32 m0, s75, 16384
s_add_u32 s77, s76, 0x8000
buffer_load_dwordx4 v148, s[56:59], s76 offen lds
buffer_load_dwordx4 v149, s[56:59], s76 offen offset:1024 lds
s_add_u32 m0, s75, 24576
s_nop 0
buffer_load_dwordx4 v148, s[56:59], s77 offen lds
buffer_load_dwordx4 v149, s[56:59], s77 offen offset:1024 lds
s_lshl_b32 s33, s35, 2
s_add_u32 s33, s33, s34
s_lshl_b32 s33, s33, 10
v_lshl_add_u32 v128, v1, 4, s33
v_add_u32 v128, 131072, v128
v_lshlrev_b32 v131, 4, v2
s_lshl_b32 s33, s35, 10
s_add_u32 s33, s33, 139264
v_add_u32 v129, s33, v131
s_lshl_b32 s33, s34, 8
v_add_u32 v130, s33, v129
s_lshl_b32 s33, s35, 12
s_add_u32 s33, s33, 131072
v_add_u32 v132, s33, v131
s_lshl_b32 s33, s35, 8
s_add_u32 s33, s33, 141312
v_add_u32 v133, s33, v131
v_lshrrev_b32 v134, 1, v3
v_lshlrev_b32 v134, 15, v134
v_and_b32 v135, 3, v2
v_lshlrev_b32 v135, 3, v135
v_and_b32 v136, 1, v3
v_lshl_add_u32 v135, v136, 2, v135
v_lshrrev_b32 v136, 2, v2
v_add_u32 v135, v135, v136
v_lshl_add_u32 v134, v135, 4, v134
v_mov_b32 v135, 0
s_sub_i32 s33, s6, 1
v_sub_u32 v140, s33, v3
v_lshlrev_b32 v112, 2, v2
v_add_u32 v143, -12, v140
v_max_i32 v143, 0, v143
v_lshl_add_u32 v143, v143, 8, v131
v_add_u32 v142, -8, v140
v_max_i32 v142, 0, v142
v_lshl_add_u32 v142, v142, 8, v131
v_add_u32 v141, -4, v140
v_max_i32 v141, 0, v141
v_lshl_add_u32 v141, v141, 8, v131
v_add_u32 v140, 0, v140
v_max_i32 v140, 0, v140
v_lshl_add_u32 v140, v140, 8, v131
v_and_b32 v137, 3, v2
v_lshlrev_b32 v137, 2, v137
v_lshrrev_b32 v136, 2, v2
v_add_u32 v137, v137, v136
s_lshl_b32 s33, s35, 4
v_add_u32 v137, s33, v137
v_lshlrev_b32 v137, 4, v137
v_add_u32 v137, 141888, v137
v_lshl_add_u32 v136, v3, 9, v137
s_lshl_b32 s33, s34, 11
v_add_u32 v138, s33, v136
v_sub_u32 v139, v137, v138
v_add_u32 v139, v139, v137
v_bfe_u32 v116, v2, 1, 1
v_lshrrev_b32 v117, 3, v2
v_lshl_add_u32 v116, v117, 1, v116
s_and_b32 s33, s39, 1
s_lshl_b32 s33, s33, 2
v_or_b32 v116, s33, v116
v_lshrrev_b32 v117, 1, v3
v_xor_b32 v116, v116, v117
v_lshlrev_b32 v116, 4, v116
v_and_b32 v117, 1, v3
v_lshl_add_u32 v116, v117, 3, v116
v_lshl_add_u32 v116, v2, 7, v116
s_lshl_b32 s33, s39, 11
v_add_u32 v116, s33, v116
s_add_u32 s76, s50, 1
s_and_b32 s76, s76, 7
s_lshl_b32 s76, s76, 7
s_add_u32 m0, s80, 32768
s_add_u32 s77, s76, s78
s_add_u32 s76, s76, s79
buffer_load_dwordx4 v144, s[52:55], s77 offen offset:0 lds
buffer_load_dwordx4 v145, s[52:55], s77 offen offset:1024 lds
buffer_load_dwordx4 v146, s[52:55], s77 offen offset:2048 lds
buffer_load_dwordx4 v147, s[52:55], s77 offen offset:3072 lds
s_add_u32 m0, s75, 49152
s_add_u32 s77, s76, 0x8000
buffer_load_dwordx4 v148, s[56:59], s76 offen lds
buffer_load_dwordx4 v149, s[56:59], s76 offen offset:1024 lds
s_add_u32 m0, s75, 57344
s_nop 0
buffer_load_dwordx4 v148, s[56:59], s77 offen lds
buffer_load_dwordx4 v149, s[56:59], s77 offen offset:1024 lds
s_waitcnt vmcnt(8)
s_barrier
s_cmp_lg_u32 s51, 0
s_cbranch_scc1 L_sk_1
v_xor_b32 v118, 0, v116
ds_read_b64 v[240:241], v118
v_xor_b32 v119, 32, v116
ds_read_b64 v[242:243], v119
v_xor_b32 v120, 64, v116
ds_read_b64 v[244:245], v120
v_xor_b32 v121, 96, v116
ds_read_b64 v[246:247], v121
L_sk_1:
s_add_u32 s76, s50, 2
s_and_b32 s76, s76, 7
s_lshl_b32 s76, s76, 7
s_add_u32 m0, s80, 65536
s_add_u32 s77, s76, s78
s_add_u32 s76, s76, s79
buffer_load_dwordx4 v144, s[52:55], s77 offen offset:0 lds
buffer_load_dwordx4 v145, s[52:55], s77 offen offset:1024 lds
buffer_load_dwordx4 v146, s[52:55], s77 offen offset:2048 lds
buffer_load_dwordx4 v147, s[52:55], s77 offen offset:3072 lds
s_add_u32 m0, s75, 81920
s_add_u32 s77, s76, 0x8000
buffer_load_dwordx4 v148, s[56:59], s76 offen lds
buffer_load_dwordx4 v149, s[56:59], s76 offen offset:1024 lds
s_add_u32 m0, s75, 90112
s_nop 0
buffer_load_dwordx4 v148, s[56:59], s77 offen lds
buffer_load_dwordx4 v149, s[56:59], s77 offen offset:1024 lds
s_add_u32 s76, s50, 3
s_and_b32 s76, s76, 7
s_lshl_b32 s76, s76, 7
s_add_u32 m0, s80, 98304
s_add_u32 s77, s76, s78
s_add_u32 s76, s76, s79
buffer_load_dwordx4 v144, s[52:55], s77 offen offset:0 lds
buffer_load_dwordx4 v145, s[52:55], s77 offen offset:1024 lds
buffer_load_dwordx4 v146, s[52:55], s77 offen offset:2048 lds
buffer_load_dwordx4 v147, s[52:55], s77 offen offset:3072 lds
s_add_u32 m0, s75, 114688
s_add_u32 s77, s76, 0x8000
buffer_load_dwordx4 v148, s[56:59], s76 offen lds
buffer_load_dwordx4 v149, s[56:59], s76 offen offset:1024 lds
s_add_u32 m0, s75, 122880
s_nop 0
buffer_load_dwordx4 v148, s[56:59], s77 offen lds
buffer_load_dwordx4 v149, s[56:59], s77 offen offset:1024 lds
s_waitcnt vmcnt(16)
s_waitcnt lgkmcnt(0)
s_barrier
s_add_u32 s76, s50, 4
s_and_b32 s76, s76, 7
s_lshl_b32 s76, s76, 7
s_add_u32 m0, s80, 0
s_add_u32 s77, s76, s78
s_add_u32 s76, s76, s79
buffer_load_dwordx4 v144, s[52:55], s77 offen offset:0 lds
buffer_load_dwordx4 v145, s[52:55], s77 offen offset:1024 lds
buffer_load_dwordx4 v146, s[52:55], s77 offen offset:2048 lds
buffer_load_dwordx4 v147, s[52:55], s77 offen offset:3072 lds
s_add_u32 m0, s75, 16384
s_add_u32 s77, s76, 0x8000
buffer_load_dwordx4 v148, s[56:59], s76 offen lds
buffer_load_dwordx4 v149, s[56:59], s76 offen offset:1024 lds
s_add_u32 m0, s75, 24576
s_nop 0
buffer_load_dwordx4 v148, s[56:59], s77 offen lds
buffer_load_dwordx4 v149, s[56:59], s77 offen offset:1024 lds
s_waitcnt vmcnt(16)
s_waitcnt lgkmcnt(0)
s_barrier
s_cmp_lg_u32 s51, 2
s_cbranch_scc1 L_sk_2
v_add_u32 v116, 0x10000, v116
v_xor_b32 v118, 0, v116
ds_read_b64 v[240:241], v118
v_xor_b32 v119, 32, v116
ds_read_b64 v[242:243], v119
v_xor_b32 v120, 64, v116
ds_read_b64 v[244:245], v120
v_xor_b32 v121, 96, v116
ds_read_b64 v[246:247], v121
L_sk_2:
s_add_u32 s76, s50, 5
s_and_b32 s76, s76, 7
s_lshl_b32 s76, s76, 7
s_add_u32 m0, s80, 32768
s_add_u32 s77, s76, s78
s_add_u32 s76, s76, s79
buffer_load_dwordx4 v144, s[52:55], s77 offen offset:0 lds
buffer_load_dwordx4 v145, s[52:55], s77 offen offset:1024 lds
buffer_load_dwordx4 v146, s[52:55], s77 offen offset:2048 lds
buffer_load_dwordx4 v147, s[52:55], s77 offen offset:3072 lds
s_add_u32 m0, s75, 49152
s_add_u32 s77, s76, 0x8000
buffer_load_dwordx4 v148, s[56:59], s76 offen lds
buffer_load_dwordx4 v149, s[56:59], s76 offen offset:1024 lds
s_add_u32 m0, s75, 57344
s_nop 0
buffer_load_dwordx4 v148, s[56:59], s77 offen lds
buffer_load_dwordx4 v149, s[56:59], s77 offen offset:1024 lds
s_waitcnt vmcnt(16)
s_waitcnt lgkmcnt(0)
s_barrier
global_load_dwordx2 v[248:249], v115, s[24:25] offset:0
global_load_dwordx2 v[250:251], v115, s[24:25] offset:32
global_load_dwordx2 v[252:253], v115, s[24:25] offset:64
global_load_dwordx2 v[254:255], v115, s[24:25] offset:96
global_load_dword v113, v112, s[46:47] offset:64 sc1
s_add_u32 s76, s50, 6
s_and_b32 s76, s76, 7
s_lshl_b32 s76, s76, 7
s_add_u32 m0, s80, 65536
s_add_u32 s77, s76, s78
s_add_u32 s76, s76, s79
buffer_load_dwordx4 v144, s[52:55], s77 offen offset:0 lds
buffer_load_dwordx4 v145, s[52:55], s77 offen offset:1024 lds
buffer_load_dwordx4 v146, s[52:55], s77 offen offset:2048 lds
buffer_load_dwordx4 v147, s[52:55], s77 offen offset:3072 lds
s_add_u32 m0, s75, 81920
s_add_u32 s77, s76, 0x8000
buffer_load_dwordx4 v148, s[56:59], s76 offen lds
buffer_load_dwordx4 v149, s[56:59], s76 offen offset:1024 lds
s_add_u32 m0, s75, 90112
s_nop 0
buffer_load_dwordx4 v148, s[56:59], s77 offen lds
buffer_load_dwordx4 v149, s[56:59], s77 offen offset:1024 lds
s_waitcnt vmcnt(21)
s_waitcnt lgkmcnt(0)
s_barrier
s_cmp_lg_u32 s51, 4
s_cbranch_scc1 L_sk_3
v_xor_b32 v118, 0, v116
ds_read_b64 v[240:241], v118
v_xor_b32 v119, 32, v116
ds_read_b64 v[242:243], v119
v_xor_b32 v120, 64, v116
ds_read_b64 v[244:245], v120
v_xor_b32 v121, 96, v116
ds_read_b64 v[246:247], v121
L_sk_3:
s_add_u32 s76, s50, 7
s_and_b32 s76, s76, 7
s_lshl_b32 s76, s76, 7
s_add_u32 m0, s80, 98304
s_add_u32 s77, s76, s78
s_add_u32 s76, s76, s79
buffer_load_dwordx4 v144, s[52:55], s77 offen offset:0 lds
buffer_load_dwordx4 v145, s[52:55], s77 offen offset:1024 lds
buffer_load_dwordx4 v146, s[52:55], s77 offen offset:2048 lds
buffer_load_dwordx4 v147, s[52:55], s77 offen offset:3072 lds
s_add_u32 m0, s75, 114688
s_add_u32 s77, s76, 0x8000
buffer_load_dwordx4 v148, s[56:59], s76 offen lds
buffer_load_dwordx4 v149, s[56:59], s76 offen offset:1024 lds
s_add_u32 m0, s75, 122880
s_nop 0
buffer_load_dwordx4 v148, s[56:59], s77 offen lds
buffer_load_dwordx4 v149, s[56:59], s77 offen offset:1024 lds
s_waitcnt vmcnt(21)
s_waitcnt lgkmcnt(0)
s_barrier
v_xor_b32 v9, 0, v8
v_add_u32 v9, s36, v9
v_and_b32 v9, 0x3ff, v9
s_add_u32 m0, s37, 0
s_add_u32 s76, s38, 0
buffer_load_dwordx4 v9, s[60:63], s76 offen lds
v_xor_b32 v9, 16, v8
v_add_u32 v9, s36, v9
v_and_b32 v9, 0x3ff, v9
s_add_u32 m0, s37, 1024
s_add_u32 s76, s38, 1024
buffer_load_dwordx4 v9, s[60:63], s76 offen lds
v_xor_b32 v9, 32, v8
v_add_u32 v9, s36, v9
v_and_b32 v9, 0x3ff, v9
s_add_u32 m0, s37, 2048
s_add_u32 s76, s38, 2048
buffer_load_dwordx4 v9, s[60:63], s76 offen lds
v_xor_b32 v9, 48, v8
v_add_u32 v9, s36, v9
v_and_b32 v9, 0x3ff, v9
s_add_u32 m0, s37, 3072
s_add_u32 s76, s38, 3072
buffer_load_dwordx4 v9, s[60:63], s76 offen lds
v_xor_b32 v9, 64, v8
v_add_u32 v9, s36, v9
v_and_b32 v9, 0x3ff, v9
s_add_u32 m0, s37, 4096
s_add_u32 s76, s38, 4096
buffer_load_dwordx4 v9, s[60:63], s76 offen lds
v_xor_b32 v9, 80, v8
v_add_u32 v9, s36, v9
v_and_b32 v9, 0x3ff, v9
s_add_u32 m0, s37, 5120
s_add_u32 s76, s38, 5120
buffer_load_dwordx4 v9, s[60:63], s76 offen lds
v_xor_b32 v9, 96, v8
v_add_u32 v9, s36, v9
v_and_b32 v9, 0x3ff, v9
s_add_u32 m0, s37, 6144
s_add_u32 s76, s38, 6144
buffer_load_dwordx4 v9, s[60:63], s76 offen lds
v_xor_b32 v9, 112, v8
v_add_u32 v9, s36, v9
v_and_b32 v9, 0x3ff, v9
s_add_u32 m0, s37, 7168
s_add_u32 s76, s38, 7168
buffer_load_dwordx4 v9, s[60:63], s76 offen lds
s_waitcnt vmcnt(16)
s_waitcnt lgkmcnt(0)
s_barrier
s_cmp_lg_u32 s51, 6
s_cbranch_scc1 L_sk_4
v_add_u32 v116, 0x10000, v116
v_xor_b32 v118, 0, v116
ds_read_b64 v[240:241], v118
v_xor_b32 v119, 32, v116
ds_read_b64 v[242:243], v119
v_xor_b32 v120, 64, v116
ds_read_b64 v[244:245], v120
v_xor_b32 v121, 96, v116
ds_read_b64 v[246:247], v121
L_sk_4:
v_xor_b32 v9, 0, v8
v_add_u32 v9, s36, v9
v_and_b32 v9, 0x3ff, v9
s_add_u32 m0, s37, 32768
s_add_u32 s76, s38, 32768
buffer_load_dwordx4 v9, s[60:63], s76 offen lds
v_xor_b32 v9, 16, v8
v_add_u32 v9, s36, v9
v_and_b32 v9, 0x3ff, v9
s_add_u32 m0, s37, 33792
s_add_u32 s76, s38, 33792
buffer_load_dwordx4 v9, s[60:63], s76 offen lds
v_xor_b32 v9, 32, v8
v_add_u32 v9, s36, v9
v_and_b32 v9, 0x3ff, v9
s_add_u32 m0, s37, 34816
s_add_u32 s76, s38, 34816
buffer_load_dwordx4 v9, s[60:63], s76 offen lds
v_xor_b32 v9, 48, v8
v_add_u32 v9, s36, v9
v_and_b32 v9, 0x3ff, v9
s_add_u32 m0, s37, 35840
s_add_u32 s76, s38, 35840
buffer_load_dwordx4 v9, s[60:63], s76 offen lds
v_xor_b32 v9, 64, v8
v_add_u32 v9, s36, v9
v_and_b32 v9, 0x3ff, v9
s_add_u32 m0, s37, 36864
s_add_u32 s76, s38, 36864
buffer_load_dwordx4 v9, s[60:63], s76 offen lds
v_xor_b32 v9, 80, v8
v_add_u32 v9, s36, v9
v_and_b32 v9, 0x3ff, v9
s_add_u32 m0, s37, 37888
s_add_u32 s76, s38, 37888
buffer_load_dwordx4 v9, s[60:63], s76 offen lds
v_xor_b32 v9, 96, v8
v_add_u32 v9, s36, v9
v_and_b32 v9, 0x3ff, v9
s_add_u32 m0, s37, 38912
s_add_u32 s76, s38, 38912
buffer_load_dwordx4 v9, s[60:63], s76 offen lds
v_xor_b32 v9, 112, v8
v_add_u32 v9, s36, v9
v_and_b32 v9, 0x3ff, v9
s_add_u32 m0, s37, 39936
s_add_u32 s76, s38, 39936
buffer_load_dwordx4 v9, s[60:63], s76 offen lds
s_waitcnt vmcnt(16)
s_waitcnt lgkmcnt(0)
s_barrier
v_xor_b32 v9, 0, v8
v_add_u32 v9, s36, v9
v_and_b32 v9, 0x3ff, v9
s_add_u32 m0, s37, 65536
s_add_u32 s76, s38, 0
buffer_load_dwordx4 v9, s[64:67], s76 offen lds
v_xor_b32 v9, 16, v8
v_add_u32 v9, s36, v9
v_and_b32 v9, 0x3ff, v9
s_add_u32 m0, s37, 66560
s_add_u32 s76, s38, 1024
buffer_load_dwordx4 v9, s[64:67], s76 offen lds
v_xor_b32 v9, 32, v8
v_add_u32 v9, s36, v9
v_and_b32 v9, 0x3ff, v9
s_add_u32 m0, s37, 67584
s_add_u32 s76, s38, 2048
buffer_load_dwordx4 v9, s[64:67], s76 offen lds
v_xor_b32 v9, 48, v8
v_add_u32 v9, s36, v9
v_and_b32 v9, 0x3ff, v9
s_add_u32 m0, s37, 68608
s_add_u32 s76, s38, 3072
buffer_load_dwordx4 v9, s[64:67], s76 offen lds
v_xor_b32 v9, 64, v8
v_add_u32 v9, s36, v9
v_and_b32 v9, 0x3ff, v9
s_add_u32 m0, s37, 69632
s_add_u32 s76, s38, 4096
buffer_load_dwordx4 v9, s[64:67], s76 offen lds
v_xor_b32 v9, 80, v8
v_add_u32 v9, s36, v9
v_and_b32 v9, 0x3ff, v9
s_add_u32 m0, s37, 70656
s_add_u32 s76, s38, 5120
buffer_load_dwordx4 v9, s[64:67], s76 offen lds
v_xor_b32 v9, 96, v8
v_add_u32 v9, s36, v9
v_and_b32 v9, 0x3ff, v9
s_add_u32 m0, s37, 71680
s_add_u32 s76, s38, 6144
buffer_load_dwordx4 v9, s[64:67], s76 offen lds
v_xor_b32 v9, 112, v8
v_add_u32 v9, s36, v9
v_and_b32 v9, 0x3ff, v9
s_add_u32 m0, s37, 72704
s_add_u32 s76, s38, 7168
buffer_load_dwordx4 v9, s[64:67], s76 offen lds
s_waitcnt lgkmcnt(0)
s_barrier
s_lshl_b32 s76, s81, 13
s_add_u32 s76, s76, 0x18000
v_lshl_add_u32 v10, v1, 4, s76
ds_read_b128 v[160:163], v137 offset:10240
ds_read_b128 v[164:167], v137 offset:10752
ds_read_b128 v[172:175], v139 offset:7680
ds_read_b128 v[168:171], v137 offset:512
ds_read_b128 v[176:179], v137 offset:11776
ds_read_b128 v[188:191], v138 offset:0
ds_read_b128 v[180:183], v137 offset:11264
ds_read_b128 v[184:187], v136 offset:8192
s_barrier
ds_read_b128 v[16:19], v10 offset:0
ds_read_b128 v[20:23], v10 offset:1024
ds_read_b128 v[24:27], v10 offset:2048
ds_read_b128 v[28:31], v10 offset:3072
ds_read_b128 v[32:35], v10 offset:4096
ds_read_b128 v[36:39], v10 offset:5120
ds_read_b128 v[40:43], v10 offset:6144
ds_read_b128 v[44:47], v10 offset:7168
s_waitcnt lgkmcnt(0)
s_branch L_A_join
L_A_comp:
s_lshl_b32 s33, s35, 2
s_add_u32 s33, s33, s34
s_lshl_b32 s33, s33, 10
v_lshl_add_u32 v128, v1, 4, s33
v_add_u32 v128, 131072, v128
v_lshlrev_b32 v131, 4, v2
s_lshl_b32 s33, s35, 10
s_add_u32 s33, s33, 139264
v_add_u32 v129, s33, v131
s_lshl_b32 s33, s34, 8
v_add_u32 v130, s33, v129
s_lshl_b32 s33, s35, 12
s_add_u32 s33, s33, 131072
v_add_u32 v132, s33, v131
s_lshl_b32 s33, s35, 8
s_add_u32 s33, s33, 141312
v_add_u32 v133, s33, v131
v_lshrrev_b32 v134, 1, v3
v_lshlrev_b32 v134, 15, v134
v_and_b32 v135, 3, v2
v_lshlrev_b32 v135, 3, v135
v_and_b32 v136, 1, v3
v_lshl_add_u32 v135, v136, 2, v135
v_lshrrev_b32 v136, 2, v2
v_add_u32 v135, v135, v136
v_lshl_add_u32 v134, v135, 4, v134
v_mov_b32 v135, 0
s_sub_i32 s33, s6, 1
v_sub_u32 v140, s33, v3
v_lshlrev_b32 v112, 2, v2
v_add_u32 v143, -12, v140
v_max_i32 v143, 0, v143
v_lshl_add_u32 v143, v143, 8, v131
v_add_u32 v142, -8, v140
v_max_i32 v142, 0, v142
v_lshl_add_u32 v142, v142, 8, v131
v_add_u32 v141, -4, v140
v_max_i32 v141, 0, v141
v_lshl_add_u32 v141, v141, 8, v131
v_add_u32 v140, 0, v140
v_max_i32 v140, 0, v140
v_lshl_add_u32 v140, v140, 8, v131
v_and_b32 v137, 3, v2
v_lshlrev_b32 v137, 2, v137
v_lshrrev_b32 v136, 2, v2
v_add_u32 v137, v137, v136
s_lshl_b32 s33, s35, 4
v_add_u32 v137, s33, v137
v_lshlrev_b32 v137, 4, v137
v_add_u32 v137, 141888, v137
v_lshl_add_u32 v136, v3, 9, v137
s_lshl_b32 s33, s34, 11
v_add_u32 v138, s33, v136
v_sub_u32 v139, v137, v138
v_add_u32 v139, v139, v137
v_bfe_u32 v116, v2, 1, 1
v_lshrrev_b32 v117, 3, v2
v_lshl_add_u32 v116, v117, 1, v116
s_and_b32 s33, s39, 1
s_lshl_b32 s33, s33, 2
v_or_b32 v116, s33, v116
v_lshrrev_b32 v117, 1, v3
v_xor_b32 v116, v116, v117
v_lshlrev_b32 v116, 4, v116
v_and_b32 v117, 1, v3
v_lshl_add_u32 v116, v117, 3, v116
v_lshl_add_u32 v116, v2, 7, v116
s_lshl_b32 s33, s39, 11
v_add_u32 v116, s33, v116
s_waitcnt vmcnt(0)
v_lshlrev_b32 v63, 3, v1
s_lshl_b32 s31, s3, 11
s_add_u32 s31, s31, 141888
v_add_u32 v63, s31, v63
v_lshlrev_b32 v58, 16, v53
v_lshlrev_b32 v59, 16, v54
v_lshlrev_b32 v55, 16, v55
v_mul_f32 v60, 0x3fb8aa3b, v55
s_mov_b32 s33, 0x3fb8aa3b
v_fma_f32 v61, v55, s33, -v60
v_fmac_f32 v61, 0x32a57060, v55
v_exp_f32 v60, v60
v_mul_f32 v61, 0x3f317218, v61
v_fma_f32 v60, v60, v61, v60
v_cvt_pk_bf16_f32 v62, v60, v60
v_lshlrev_b32 v62, 16, v62
v_mul_f32 v56, v62, v58
v_mul_f32 v57, v62, v59
v_mul_f32 v56, 0x3fb8aa3b, v56
v_mul_f32 v57, 0x3e22f983, v57
v_mul_f32 v60, 1.0, v56
v_mul_f32 v61, 1.0, v57
v_exp_f32 v60, v60
v_fract_f32 v61, v61
v_cos_f32 v66, v61
v_sin_f32 v67, v61
v_mul_f32 v66, v60, v66
v_mul_f32 v67, v60, v67
v_add_f32 v60, -1.0, v66
v_mul_f32 v61, v58, v58
v_fmac_f32 v61, v59, v59
v_rcp_f32 v61, v61
v_mul_f32 v68, v60, v58
v_fmac_f32 v68, v67, v59
v_mul_f32 v69, v67, v58
v_fma_f32 v69, -v60, v59, v69
v_add_f32 v61, v61, v61
v_mul_f32 v68, v68, v61
v_mul_f32 v69, v69, v61
s_add_u32 s30, s3, 0
s_lshl_b32 s26, s30, 5
s_mov_b32 s32, 8
s_cmp_eq_u32 s30, 4
s_cselect_b32 s26, 0, s26
s_cselect_b32 s32, 128, s32
s_cmp_ge_u32 s30, 6
s_cselect_b64 s[96:97], -1, 0
s_cselect_b32 s32, 1, s32
s_lshl_b32 s33, s30, 2
s_sub_u32 s33, s33, 23
s_cmp_ge_u32 s30, 6
s_cselect_b32 s26, s33, s26
s_add_u32 s27, s26, s32
s_add_u32 s28, s27, s32
s_add_u32 s29, s28, s32
s_cmp_ge_u32 s30, 5
s_cselect_b64 s[98:99], -1, 0
s_cmp_eq_u32 s30, 5
s_cselect_b32 s26, 1, s26
s_cselect_b32 s27, 2, s27
s_cselect_b32 s28, 0x200, s28
s_cselect_b32 s29, 0, s29
v_cvt_f32_u32 v65, s26
v_mul_f32 v60, v65, v56
v_mul_f32 v61, v65, v57
v_exp_f32 v60, v60
v_fract_f32 v61, v61
v_cos_f32 v72, v61
v_sin_f32 v73, v61
v_mul_f32 v72, v60, v72
v_mul_f32 v73, v60, v73
ds_write_b64 v63, v[72:73] offset:0
v_cvt_f32_u32 v65, s27
v_mul_f32 v60, v65, v56
v_mul_f32 v61, v65, v57
v_exp_f32 v60, v60
v_fract_f32 v61, v61
v_cos_f32 v72, v61
v_sin_f32 v73, v61
v_mul_f32 v72, v60, v72
v_mul_f32 v73, v60, v73
ds_write_b64 v63, v[72:73] offset:512
v_cvt_f32_u32 v65, s28
v_mul_f32 v60, v65, v56
v_mul_f32 v61, v65, v57
v_exp_f32 v60, v60
v_fract_f32 v61, v61
v_cos_f32 v72, v61
v_sin_f32 v73, v61
v_mul_f32 v72, v60, v72
v_mul_f32 v73, v60, v73
ds_write_b64 v63, v[72:73] offset:1024
v_cvt_f32_u32 v65, s29
v_mul_f32 v60, v65, v56
v_mul_f32 v61, v65, v57
v_exp_f32 v60, v60
v_fract_f32 v61, v61
v_cos_f32 v72, v61
v_sin_f32 v73, v61
v_mul_f32 v72, v60, v72
v_mul_f32 v73, v60, v73
ds_write_b64 v63, v[72:73] offset:1536
s_add_u32 s30, s3, 4
s_lshl_b32 s26, s30, 5
s_mov_b32 s32, 8
s_cmp_eq_u32 s30, 4
s_cselect_b32 s26, 0, s26
s_cselect_b32 s32, 128, s32
s_cmp_ge_u32 s30, 6
s_cselect_b64 s[96:97], -1, 0
s_cselect_b32 s32, 1, s32
s_lshl_b32 s33, s30, 2
s_sub_u32 s33, s33, 23
s_cmp_ge_u32 s30, 6
s_cselect_b32 s26, s33, s26
s_add_u32 s27, s26, s32
s_add_u32 s28, s27, s32
s_add_u32 s29, s28, s32
s_cmp_ge_u32 s30, 5
s_cselect_b64 s[98:99], -1, 0
s_cmp_eq_u32 s30, 5
s_cselect_b32 s26, 1, s26
s_cselect_b32 s27, 2, s27
s_cselect_b32 s28, 0x200, s28
s_cselect_b32 s29, 0, s29
v_cvt_f32_u32 v65, s26
v_mul_f32 v60, v65, v56
v_mul_f32 v61, v65, v57
v_exp_f32 v60, v60
v_fract_f32 v61, v61
v_cos_f32 v72, v61
v_sin_f32 v73, v61
v_mul_f32 v72, v60, v72
v_mul_f32 v73, v60, v73
v_cndmask_b32 v70, 1.0, v68, s[96:97]
v_cndmask_b32 v71, 0, v69, s[96:97]
v_mul_f32 v74, v72, v70
v_mul_f32 v75, v72, v71
v_fma_f32 v74, -v73, v71, v74
v_fma_f32 v75, v73, v70, v75
ds_write_b64 v63, v[74:75] offset:8192
v_cvt_f32_u32 v65, s27
v_mul_f32 v60, v65, v56
v_mul_f32 v61, v65, v57
v_exp_f32 v60, v60
v_fract_f32 v61, v61
v_cos_f32 v72, v61
v_sin_f32 v73, v61
v_mul_f32 v72, v60, v72
v_mul_f32 v73, v60, v73
v_cndmask_b32 v70, 1.0, v68, s[96:97]
v_cndmask_b32 v71, 0, v69, s[96:97]
v_mul_f32 v74, v72, v70
v_mul_f32 v75, v72, v71
v_fma_f32 v74, -v73, v71, v74
v_fma_f32 v75, v73, v70, v75
ds_write_b64 v63, v[74:75] offset:8704
v_cvt_f32_u32 v65, s28
v_mul_f32 v60, v65, v56
v_mul_f32 v61, v65, v57
v_exp_f32 v60, v60
v_fract_f32 v61, v61
v_cos_f32 v72, v61
v_sin_f32 v73, v61
v_mul_f32 v72, v60, v72
v_mul_f32 v73, v60, v73
v_cndmask_b32 v70, 1.0, v68, s[96:97]
v_cndmask_b32 v71, 0, v69, s[96:97]
v_mul_f32 v74, v72, v70
v_mul_f32 v75, v72, v71
v_fma_f32 v74, -v73, v71, v74
v_fma_f32 v75, v73, v70, v75
ds_write_b64 v63, v[74:75] offset:9216
v_cvt_f32_u32 v65, s29
v_mul_f32 v60, v65, v56
v_mul_f32 v61, v65, v57
v_exp_f32 v60, v60
v_fract_f32 v61, v61
v_cos_f32 v72, v61
v_sin_f32 v73, v61
v_mul_f32 v72, v60, v72
v_mul_f32 v73, v60, v73
v_cndmask_b32 v70, 1.0, v68, s[98:99]
v_cndmask_b32 v71, 0, v69, s[98:99]
v_mul_f32 v74, v72, v70
v_mul_f32 v75, v72, v71
v_fma_f32 v74, -v73, v71, v74
v_fma_f32 v75, v73, v70, v75
ds_write_b64 v63, v[74:75] offset:9728
s_waitcnt lgkmcnt(0)
s_barrier
ds_read_b128 v[144:147], v12 offset:0
ds_read_b128 v[160:163], v14 offset:0
ds_read_b128 v[148:151], v12 offset:512
ds_read_b128 v[152:155], v12 offset:4096
ds_read_b128 v[156:159], v12 offset:4608
ds_read_b128 v[164:167], v14 offset:2048
ds_read_b128 v[168:171], v14 offset:4096
ds_read_b128 v[172:175], v14 offset:6144
ds_read_b128 v[176:179], v13 offset:0
ds_read_b128 v[192:195], v15 offset:0
ds_read_b128 v[180:183], v13 offset:512
ds_read_b128 v[184:187], v13 offset:4096
ds_read_b128 v[188:191], v13 offset:4608
ds_read_b128 v[228:231], v15 offset:2048
ds_read_b128 v[232:235], v15 offset:4096
ds_read_b128 v[236:239], v15 offset:6144
s_cmp_lg_u32 s51, 0
s_cbranch_scc1 L_sk_5
v_xor_b32 v118, 0, v116
ds_read_b64 v[240:241], v118
v_xor_b32 v119, 32, v116
ds_read_b64 v[242:243], v119
v_xor_b32 v120, 64, v116
ds_read_b64 v[244:245], v120
v_xor_b32 v121, 96, v116
ds_read_b64 v[246:247], v121
L_sk_5:
s_waitcnt lgkmcnt(0)
s_barrier
v_mfma_f32_16x16x32_bf16 v[16:19], v[144:147], v[160:163], 0
ds_read_b128 v[48:51], v12 offset:32768
v_mfma_f32_16x16x32_bf16 v[32:35], v[148:151], v[160:163], 0
ds_read_b128 v[64:67], v14 offset:32768
v_mfma_f32_16x16x32_bf16 v[196:199], v[152:155], v[160:163], 0
ds_read_b128 v[52:55], v12 offset:33280
v_mfma_f32_16x16x32_bf16 v[212:215], v[156:159], v[160:163], 0
ds_read_b128 v[56:59], v12 offset:36864
v_mfma_f32_16x16x32_bf16 v[20:23], v[144:147], v[164:167], 0
ds_read_b128 v[60:63], v12 offset:37376
v_mfma_f32_16x16x32_bf16 v[36:39], v[148:151], v[164:167], 0
ds_read_b128 v[68:71], v14 offset:34816
v_mfma_f32_16x16x32_bf16 v[200:203], v[152:155], v[164:167], 0
ds_read_b128 v[72:75], v14 offset:36864
v_mfma_f32_16x16x32_bf16 v[216:219], v[156:159], v[164:167], 0
ds_read_b128 v[76:79], v14 offset:38912
v_mfma_f32_16x16x32_bf16 v[24:27], v[144:147], v[168:171], 0
ds_read_b128 v[80:83], v13 offset:32768
v_mfma_f32_16x16x32_bf16 v[40:43], v[148:151], v[168:171], 0
ds_read_b128 v[96:99], v15 offset:32768
v_mfma_f32_16x16x32_bf16 v[204:207], v[152:155], v[168:171], 0
ds_read_b128 v[84:87], v13 offset:33280
v_mfma_f32_16x16x32_bf16 v[220:223], v[156:159], v[168:171], 0
ds_read_b128 v[88:91], v13 offset:36864
v_mfma_f32_16x16x32_bf16 v[28:31], v[144:147], v[172:175], 0
ds_read_b128 v[92:95], v13 offset:37376
v_mfma_f32_16x16x32_bf16 v[44:47], v[148:151], v[172:175], 0
ds_read_b128 v[100:103], v15 offset:34816
v_mfma_f32_16x16x32_bf16 v[208:211], v[152:155], v[172:175], 0
ds_read_b128 v[104:107], v15 offset:36864
v_mfma_f32_16x16x32_bf16 v[224:227], v[156:159], v[172:175], 0
ds_read_b128 v[108:111], v15 offset:38912
v_mfma_f32_16x16x32_bf16 v[16:19], v[176:179], v[192:195], v[16:19]
v_mfma_f32_16x16x32_bf16 v[32:35], v[180:183], v[192:195], v[32:35]
v_mfma_f32_16x16x32_bf16 v[196:199], v[184:187], v[192:195], v[196:199]
v_mfma_f32_16x16x32_bf16 v[212:215], v[188:191], v[192:195], v[212:215]
v_mfma_f32_16x16x32_bf16 v[20:23], v[176:179], v[228:231], v[20:23]
v_mfma_f32_16x16x32_bf16 v[36:39], v[180:183], v[228:231], v[36:39]
v_mfma_f32_16x16x32_bf16 v[200:203], v[184:187], v[228:231], v[200:203]
v_mfma_f32_16x16x32_bf16 v[216:219], v[188:191], v[228:231], v[216:219]
v_mfma_f32_16x16x32_bf16 v[24:27], v[176:179], v[232:235], v[24:27]
v_mfma_f32_16x16x32_bf16 v[40:43], v[180:183], v[232:235], v[40:43]
v_mfma_f32_16x16x32_bf16 v[204:207], v[184:187], v[232:235], v[204:207]
v_mfma_f32_16x16x32_bf16 v[220:223], v[188:191], v[232:235], v[220:223]
v_mfma_f32_16x16x32_bf16 v[28:31], v[176:179], v[236:239], v[28:31]
v_mfma_f32_16x16x32_bf16 v[44:47], v[180:183], v[236:239], v[44:47]
v_mfma_f32_16x16x32_bf16 v[208:211], v[184:187], v[236:239], v[208:211]
v_mfma_f32_16x16x32_bf16 v[224:227], v[188:191], v[236:239], v[224:227]
s_waitcnt lgkmcnt(0)
s_barrier
v_mfma_f32_16x16x32_bf16 v[16:19], v[48:51], v[64:67], v[16:19]
ds_read_b128 v[144:147], v124 offset:0
v_mfma_f32_16x16x32_bf16 v[32:35], v[52:55], v[64:67], v[32:35]
ds_read_b128 v[160:163], v126 offset:0
v_mfma_f32_16x16x32_bf16 v[196:199], v[56:59], v[64:67], v[196:199]
ds_read_b128 v[148:151], v124 offset:512
v_mfma_f32_16x16x32_bf16 v[212:215], v[60:63], v[64:67], v[212:215]
ds_read_b128 v[152:155], v124 offset:4096
v_mfma_f32_16x16x32_bf16 v[20:23], v[48:51], v[68:71], v[20:23]
ds_read_b128 v[156:159], v124 offset:4608
v_mfma_f32_16x16x32_bf16 v[36:39], v[52:55], v[68:71], v[36:39]
ds_read_b128 v[164:167], v126 offset:2048
v_mfma_f32_16x16x32_bf16 v[200:203], v[56:59], v[68:71], v[200:203]
ds_read_b128 v[168:171], v126 offset:4096
v_mfma_f32_16x16x32_bf16 v[216:219], v[60:63], v[68:71], v[216:219]
ds_read_b128 v[172:175], v126 offset:6144
v_mfma_f32_16x16x32_bf16 v[24:27], v[48:51], v[72:75], v[24:27]
ds_read_b128 v[176:179], v125 offset:0
v_mfma_f32_16x16x32_bf16 v[40:43], v[52:55], v[72:75], v[40:43]
ds_read_b128 v[192:195], v127 offset:0
v_mfma_f32_16x16x32_bf16 v[204:207], v[56:59], v[72:75], v[204:207]
ds_read_b128 v[180:183], v125 offset:512
v_mfma_f32_16x16x32_bf16 v[220:223], v[60:63], v[72:75], v[220:223]
ds_read_b128 v[184:187], v125 offset:4096
v_mfma_f32_16x16x32_bf16 v[28:31], v[48:51], v[76:79], v[28:31]
ds_read_b128 v[188:191], v125 offset:4608
v_mfma_f32_16x16x32_bf16 v[44:47], v[52:55], v[76:79], v[44:47]
ds_read_b128 v[228:231], v127 offset:2048
v_mfma_f32_16x16x32_bf16 v[208:211], v[56:59], v[76:79], v[208:211]
ds_read_b128 v[232:235], v127 offset:4096
v_mfma_f32_16x16x32_bf16 v[224:227], v[60:63], v[76:79], v[224:227]
ds_read_b128 v[236:239], v127 offset:6144
v_mfma_f32_16x16x32_bf16 v[16:19], v[80:83], v[96:99], v[16:19]
v_mfma_f32_16x16x32_bf16 v[32:35], v[84:87], v[96:99], v[32:35]
v_mfma_f32_16x16x32_bf16 v[196:199], v[88:91], v[96:99], v[196:199]
v_mfma_f32_16x16x32_bf16 v[212:215], v[92:95], v[96:99], v[212:215]
v_mfma_f32_16x16x32_bf16 v[20:23], v[80:83], v[100:103], v[20:23]
s_cmp_lg_u32 s51, 2
s_cbranch_scc1 L_sk_6
v_add_u32 v116, 0x10000, v116
v_xor_b32 v118, 0, v116
ds_read_b64 v[240:241], v118
v_xor_b32 v119, 32, v116
ds_read_b64 v[242:243], v119
v_xor_b32 v120, 64, v116
ds_read_b64 v[244:245], v120
v_xor_b32 v121, 96, v116
ds_read_b64 v[246:247], v121
L_sk_6:
v_mfma_f32_16x16x32_bf16 v[36:39], v[84:87], v[100:103], v[36:39]
v_mfma_f32_16x16x32_bf16 v[200:203], v[88:91], v[100:103], v[200:203]
v_mfma_f32_16x16x32_bf16 v[216:219], v[92:95], v[100:103], v[216:219]
v_mfma_f32_16x16x32_bf16 v[24:27], v[80:83], v[104:107], v[24:27]
v_mfma_f32_16x16x32_bf16 v[40:43], v[84:87], v[104:107], v[40:43]
v_mfma_f32_16x16x32_bf16 v[204:207], v[88:91], v[104:107], v[204:207]
v_mfma_f32_16x16x32_bf16 v[220:223], v[92:95], v[104:107], v[220:223]
v_mfma_f32_16x16x32_bf16 v[28:31], v[80:83], v[108:111], v[28:31]
v_mfma_f32_16x16x32_bf16 v[44:47], v[84:87], v[108:111], v[44:47]
v_mfma_f32_16x16x32_bf16 v[208:211], v[88:91], v[108:111], v[208:211]
v_mfma_f32_16x16x32_bf16 v[224:227], v[92:95], v[108:111], v[224:227]
s_waitcnt lgkmcnt(0)
s_barrier
v_mfma_f32_16x16x32_bf16 v[16:19], v[144:147], v[160:163], v[16:19]
ds_read_b128 v[48:51], v124 offset:32768
v_mfma_f32_16x16x32_bf16 v[32:35], v[148:151], v[160:163], v[32:35]
ds_read_b128 v[64:67], v126 offset:32768
v_mfma_f32_16x16x32_bf16 v[196:199], v[152:155], v[160:163], v[196:199]
ds_read_b128 v[52:55], v124 offset:33280
v_mfma_f32_16x16x32_bf16 v[212:215], v[156:159], v[160:163], v[212:215]
ds_read_b128 v[56:59], v124 offset:36864
v_mfma_f32_16x16x32_bf16 v[20:23], v[144:147], v[164:167], v[20:23]
ds_read_b128 v[60:63], v124 offset:37376
v_mfma_f32_16x16x32_bf16 v[36:39], v[148:151], v[164:167], v[36:39]
ds_read_b128 v[68:71], v126 offset:34816
v_mfma_f32_16x16x32_bf16 v[200:203], v[152:155], v[164:167], v[200:203]
ds_read_b128 v[72:75], v126 offset:36864
v_mfma_f32_16x16x32_bf16 v[216:219], v[156:159], v[164:167], v[216:219]
ds_read_b128 v[76:79], v126 offset:38912
v_mfma_f32_16x16x32_bf16 v[24:27], v[144:147], v[168:171], v[24:27]
ds_read_b128 v[80:83], v125 offset:32768
v_mfma_f32_16x16x32_bf16 v[40:43], v[148:151], v[168:171], v[40:43]
ds_read_b128 v[96:99], v127 offset:32768
v_mfma_f32_16x16x32_bf16 v[204:207], v[152:155], v[168:171], v[204:207]
ds_read_b128 v[84:87], v125 offset:33280
v_mfma_f32_16x16x32_bf16 v[220:223], v[156:159], v[168:171], v[220:223]
ds_read_b128 v[88:91], v125 offset:36864
v_mfma_f32_16x16x32_bf16 v[28:31], v[144:147], v[172:175], v[28:31]
ds_read_b128 v[92:95], v125 offset:37376
v_mfma_f32_16x16x32_bf16 v[44:47], v[148:151], v[172:175], v[44:47]
ds_read_b128 v[100:103], v127 offset:34816
v_mfma_f32_16x16x32_bf16 v[208:211], v[152:155], v[172:175], v[208:211]
ds_read_b128 v[104:107], v127 offset:36864
v_mfma_f32_16x16x32_bf16 v[224:227], v[156:159], v[172:175], v[224:227]
ds_read_b128 v[108:111], v127 offset:38912
v_mfma_f32_16x16x32_bf16 v[16:19], v[176:179], v[192:195], v[16:19]
v_mfma_f32_16x16x32_bf16 v[32:35], v[180:183], v[192:195], v[32:35]
global_load_dword v113, v112, s[46:47] offset:64 sc1
v_mfma_f32_16x16x32_bf16 v[196:199], v[184:187], v[192:195], v[196:199]
v_mfma_f32_16x16x32_bf16 v[212:215], v[188:191], v[192:195], v[212:215]
global_load_dwordx2 v[248:249], v115, s[24:25] offset:0
v_mfma_f32_16x16x32_bf16 v[20:23], v[176:179], v[228:231], v[20:23]
v_mfma_f32_16x16x32_bf16 v[36:39], v[180:183], v[228:231], v[36:39]
v_mfma_f32_16x16x32_bf16 v[200:203], v[184:187], v[228:231], v[200:203]
v_mfma_f32_16x16x32_bf16 v[216:219], v[188:191], v[228:231], v[216:219]
global_load_dwordx2 v[250:251], v115, s[24:25] offset:32
v_mfma_f32_16x16x32_bf16 v[24:27], v[176:179], v[232:235], v[24:27]
v_mfma_f32_16x16x32_bf16 v[40:43], v[180:183], v[232:235], v[40:43]
v_mfma_f32_16x16x32_bf16 v[204:207], v[184:187], v[232:235], v[204:207]
v_mfma_f32_16x16x32_bf16 v[220:223], v[188:191], v[232:235], v[220:223]
global_load_dwordx2 v[252:253], v115, s[24:25] offset:64
v_mfma_f32_16x16x32_bf16 v[28:31], v[176:179], v[236:239], v[28:31]
v_mfma_f32_16x16x32_bf16 v[44:47], v[180:183], v[236:239], v[44:47]
v_mfma_f32_16x16x32_bf16 v[208:211], v[184:187], v[236:239], v[208:211]
v_mfma_f32_16x16x32_bf16 v[224:227], v[188:191], v[236:239], v[224:227]
global_load_dwordx2 v[254:255], v115, s[24:25] offset:96
s_waitcnt lgkmcnt(0)
s_barrier
v_mfma_f32_16x16x32_bf16 v[16:19], v[48:51], v[64:67], v[16:19]
ds_read_b128 v[144:147], v12 offset:0
v_mfma_f32_16x16x32_bf16 v[32:35], v[52:55], v[64:67], v[32:35]
ds_read_b128 v[160:163], v14 offset:0
v_mfma_f32_16x16x32_bf16 v[196:199], v[56:59], v[64:67], v[196:199]
ds_read_b128 v[148:151], v12 offset:512
v_mfma_f32_16x16x32_bf16 v[212:215], v[60:63], v[64:67], v[212:215]
ds_read_b128 v[152:155], v12 offset:4096
v_mfma_f32_16x16x32_bf16 v[20:23], v[48:51], v[68:71], v[20:23]
ds_read_b128 v[156:159], v12 offset:4608
v_mfma_f32_16x16x32_bf16 v[36:39], v[52:55], v[68:71], v[36:39]
ds_read_b128 v[164:167], v14 offset:2048
v_mfma_f32_16x16x32_bf16 v[200:203], v[56:59], v[68:71], v[200:203]
ds_read_b128 v[168:171], v14 offset:4096
v_mfma_f32_16x16x32_bf16 v[216:219], v[60:63], v[68:71], v[216:219]
ds_read_b128 v[172:175], v14 offset:6144
v_mfma_f32_16x16x32_bf16 v[24:27], v[48:51], v[72:75], v[24:27]
ds_read_b128 v[176:179], v13 offset:0
v_mfma_f32_16x16x32_bf16 v[40:43], v[52:55], v[72:75], v[40:43]
ds_read_b128 v[192:195], v15 offset:0
v_mfma_f32_16x16x32_bf16 v[204:207], v[56:59], v[72:75], v[204:207]
ds_read_b128 v[180:183], v13 offset:512
v_mfma_f32_16x16x32_bf16 v[220:223], v[60:63], v[72:75], v[220:223]
ds_read_b128 v[184:187], v13 offset:4096
v_mfma_f32_16x16x32_bf16 v[28:31], v[48:51], v[76:79], v[28:31]
ds_read_b128 v[188:191], v13 offset:4608
v_mfma_f32_16x16x32_bf16 v[44:47], v[52:55], v[76:79], v[44:47]
ds_read_b128 v[228:231], v15 offset:2048
v_mfma_f32_16x16x32_bf16 v[208:211], v[56:59], v[76:79], v[208:211]
ds_read_b128 v[232:235], v15 offset:4096
v_mfma_f32_16x16x32_bf16 v[224:227], v[60:63], v[76:79], v[224:227]
ds_read_b128 v[236:239], v15 offset:6144
v_mfma_f32_16x16x32_bf16 v[16:19], v[80:83], v[96:99], v[16:19]
v_mfma_f32_16x16x32_bf16 v[32:35], v[84:87], v[96:99], v[32:35]
v_mfma_f32_16x16x32_bf16 v[196:199], v[88:91], v[96:99], v[196:199]
v_mfma_f32_16x16x32_bf16 v[212:215], v[92:95], v[96:99], v[212:215]
v_mfma_f32_16x16x32_bf16 v[20:23], v[80:83], v[100:103], v[20:23]
s_cmp_lg_u32 s51, 4
s_cbranch_scc1 L_sk_7
v_xor_b32 v118, 0, v116
ds_read_b64 v[240:241], v118
v_xor_b32 v119, 32, v116
ds_read_b64 v[242:243], v119
v_xor_b32 v120, 64, v116
ds_read_b64 v[244:245], v120
v_xor_b32 v121, 96, v116
ds_read_b64 v[246:247], v121
L_sk_7:
v_mfma_f32_16x16x32_bf16 v[36:39], v[84:87], v[100:103], v[36:39]
v_mfma_f32_16x16x32_bf16 v[200:203], v[88:91], v[100:103], v[200:203]
v_mfma_f32_16x16x32_bf16 v[216:219], v[92:95], v[100:103], v[216:219]
v_mfma_f32_16x16x32_bf16 v[24:27], v[80:83], v[104:107], v[24:27]
v_mfma_f32_16x16x32_bf16 v[40:43], v[84:87], v[104:107], v[40:43]
v_mfma_f32_16x16x32_bf16 v[204:207], v[88:91], v[104:107], v[204:207]
v_mfma_f32_16x16x32_bf16 v[220:223], v[92:95], v[104:107], v[220:223]
v_mfma_f32_16x16x32_bf16 v[28:31], v[80:83], v[108:111], v[28:31]
v_mfma_f32_16x16x32_bf16 v[44:47], v[84:87], v[108:111], v[44:47]
v_mfma_f32_16x16x32_bf16 v[208:211], v[88:91], v[108:111], v[208:211]
v_mfma_f32_16x16x32_bf16 v[224:227], v[92:95], v[108:111], v[224:227]
s_waitcnt lgkmcnt(0)
s_barrier
v_mfma_f32_16x16x32_bf16 v[16:19], v[144:147], v[160:163], v[16:19]
ds_read_b128 v[48:51], v12 offset:32768
v_mfma_f32_16x16x32_bf16 v[32:35], v[148:151], v[160:163], v[32:35]
ds_read_b128 v[64:67], v14 offset:32768
v_mfma_f32_16x16x32_bf16 v[196:199], v[152:155], v[160:163], v[196:199]
ds_read_b128 v[52:55], v12 offset:33280
v_mfma_f32_16x16x32_bf16 v[212:215], v[156:159], v[160:163], v[212:215]
ds_read_b128 v[56:59], v12 offset:36864
v_mfma_f32_16x16x32_bf16 v[20:23], v[144:147], v[164:167], v[20:23]
ds_read_b128 v[60:63], v12 offset:37376
v_mfma_f32_16x16x32_bf16 v[36:39], v[148:151], v[164:167], v[36:39]
ds_read_b128 v[68:71], v14 offset:34816
v_mfma_f32_16x16x32_bf16 v[200:203], v[152:155], v[164:167], v[200:203]
ds_read_b128 v[72:75], v14 offset:36864
v_mfma_f32_16x16x32_bf16 v[216:219], v[156:159], v[164:167], v[216:219]
ds_read_b128 v[76:79], v14 offset:38912
v_mfma_f32_16x16x32_bf16 v[24:27], v[144:147], v[168:171], v[24:27]
ds_read_b128 v[80:83], v13 offset:32768
v_mfma_f32_16x16x32_bf16 v[40:43], v[148:151], v[168:171], v[40:43]
ds_read_b128 v[96:99], v15 offset:32768
v_mfma_f32_16x16x32_bf16 v[204:207], v[152:155], v[168:171], v[204:207]
ds_read_b128 v[84:87], v13 offset:33280
v_mfma_f32_16x16x32_bf16 v[220:223], v[156:159], v[168:171], v[220:223]
ds_read_b128 v[88:91], v13 offset:36864
v_mfma_f32_16x16x32_bf16 v[28:31], v[144:147], v[172:175], v[28:31]
ds_read_b128 v[92:95], v13 offset:37376
v_mfma_f32_16x16x32_bf16 v[44:47], v[148:151], v[172:175], v[44:47]
ds_read_b128 v[100:103], v15 offset:34816
v_mfma_f32_16x16x32_bf16 v[208:211], v[152:155], v[172:175], v[208:211]
ds_read_b128 v[104:107], v15 offset:36864
v_mfma_f32_16x16x32_bf16 v[224:227], v[156:159], v[172:175], v[224:227]
ds_read_b128 v[108:111], v15 offset:38912
v_mfma_f32_16x16x32_bf16 v[16:19], v[176:179], v[192:195], v[16:19]
v_mfma_f32_16x16x32_bf16 v[32:35], v[180:183], v[192:195], v[32:35]
v_mfma_f32_16x16x32_bf16 v[196:199], v[184:187], v[192:195], v[196:199]
v_mfma_f32_16x16x32_bf16 v[212:215], v[188:191], v[192:195], v[212:215]
v_mfma_f32_16x16x32_bf16 v[20:23], v[176:179], v[228:231], v[20:23]
v_mfma_f32_16x16x32_bf16 v[36:39], v[180:183], v[228:231], v[36:39]
v_mfma_f32_16x16x32_bf16 v[200:203], v[184:187], v[228:231], v[200:203]
v_mfma_f32_16x16x32_bf16 v[216:219], v[188:191], v[228:231], v[216:219]
v_mfma_f32_16x16x32_bf16 v[24:27], v[176:179], v[232:235], v[24:27]
v_mfma_f32_16x16x32_bf16 v[40:43], v[180:183], v[232:235], v[40:43]
v_mfma_f32_16x16x32_bf16 v[204:207], v[184:187], v[232:235], v[204:207]
v_mfma_f32_16x16x32_bf16 v[220:223], v[188:191], v[232:235], v[220:223]
v_mfma_f32_16x16x32_bf16 v[28:31], v[176:179], v[236:239], v[28:31]
v_mfma_f32_16x16x32_bf16 v[44:47], v[180:183], v[236:239], v[44:47]
v_mfma_f32_16x16x32_bf16 v[208:211], v[184:187], v[236:239], v[208:211]
v_mfma_f32_16x16x32_bf16 v[224:227], v[188:191], v[236:239], v[224:227]
s_waitcnt lgkmcnt(0)
s_barrier
v_mfma_f32_16x16x32_bf16 v[16:19], v[48:51], v[64:67], v[16:19]
ds_read_b128 v[144:147], v124 offset:0
v_mfma_f32_16x16x32_bf16 v[32:35], v[52:55], v[64:67], v[32:35]
ds_read_b128 v[160:163], v126 offset:0
v_mfma_f32_16x16x32_bf16 v[196:199], v[56:59], v[64:67], v[196:199]
ds_read_b128 v[148:151], v124 offset:512
v_mfma_f32_16x16x32_bf16 v[212:215], v[60:63], v[64:67], v[212:215]
ds_read_b128 v[152:155], v124 offset:4096
v_mfma_f32_16x16x32_bf16 v[20:23], v[48:51], v[68:71], v[20:23]
ds_read_b128 v[156:159], v124 offset:4608
v_mfma_f32_16x16x32_bf16 v[36:39], v[52:55], v[68:71], v[36:39]
ds_read_b128 v[164:167], v126 offset:2048
v_mfma_f32_16x16x32_bf16 v[200:203], v[56:59], v[68:71], v[200:203]
ds_read_b128 v[168:171], v126 offset:4096
v_mfma_f32_16x16x32_bf16 v[216:219], v[60:63], v[68:71], v[216:219]
ds_read_b128 v[172:175], v126 offset:6144
v_mfma_f32_16x16x32_bf16 v[24:27], v[48:51], v[72:75], v[24:27]
ds_read_b128 v[176:179], v125 offset:0
v_mfma_f32_16x16x32_bf16 v[40:43], v[52:55], v[72:75], v[40:43]
ds_read_b128 v[192:195], v127 offset:0
v_mfma_f32_16x16x32_bf16 v[204:207], v[56:59], v[72:75], v[204:207]
ds_read_b128 v[180:183], v125 offset:512
v_mfma_f32_16x16x32_bf16 v[220:223], v[60:63], v[72:75], v[220:223]
ds_read_b128 v[184:187], v125 offset:4096
v_mfma_f32_16x16x32_bf16 v[28:31], v[48:51], v[76:79], v[28:31]
ds_read_b128 v[188:191], v125 offset:4608
v_mfma_f32_16x16x32_bf16 v[44:47], v[52:55], v[76:79], v[44:47]
ds_read_b128 v[228:231], v127 offset:2048
v_mfma_f32_16x16x32_bf16 v[208:211], v[56:59], v[76:79], v[208:211]
ds_read_b128 v[232:235], v127 offset:4096
v_mfma_f32_16x16x32_bf16 v[224:227], v[60:63], v[76:79], v[224:227]
ds_read_b128 v[236:239], v127 offset:6144
v_mfma_f32_16x16x32_bf16 v[16:19], v[80:83], v[96:99], v[16:19]
v_mfma_f32_16x16x32_bf16 v[32:35], v[84:87], v[96:99], v[32:35]
v_mfma_f32_16x16x32_bf16 v[196:199], v[88:91], v[96:99], v[196:199]
v_mfma_f32_16x16x32_bf16 v[212:215], v[92:95], v[96:99], v[212:215]
v_mfma_f32_16x16x32_bf16 v[20:23], v[80:83], v[100:103], v[20:23]
s_cmp_lg_u32 s51, 6
s_cbranch_scc1 L_sk_8
v_add_u32 v116, 0x10000, v116
v_xor_b32 v118, 0, v116
ds_read_b64 v[240:241], v118
v_xor_b32 v119, 32, v116
ds_read_b64 v[242:243], v119
v_xor_b32 v120, 64, v116
ds_read_b64 v[244:245], v120
v_xor_b32 v121, 96, v116
ds_read_b64 v[246:247], v121
L_sk_8:
v_mfma_f32_16x16x32_bf16 v[36:39], v[84:87], v[100:103], v[36:39]
v_mfma_f32_16x16x32_bf16 v[200:203], v[88:91], v[100:103], v[200:203]
v_mfma_f32_16x16x32_bf16 v[216:219], v[92:95], v[100:103], v[216:219]
v_mfma_f32_16x16x32_bf16 v[24:27], v[80:83], v[104:107], v[24:27]
v_mfma_f32_16x16x32_bf16 v[40:43], v[84:87], v[104:107], v[40:43]
v_mfma_f32_16x16x32_bf16 v[204:207], v[88:91], v[104:107], v[204:207]
v_mfma_f32_16x16x32_bf16 v[220:223], v[92:95], v[104:107], v[220:223]
v_mfma_f32_16x16x32_bf16 v[28:31], v[80:83], v[108:111], v[28:31]
v_mfma_f32_16x16x32_bf16 v[44:47], v[84:87], v[108:111], v[44:47]
v_mfma_f32_16x16x32_bf16 v[208:211], v[88:91], v[108:111], v[208:211]
v_mfma_f32_16x16x32_bf16 v[224:227], v[92:95], v[108:111], v[224:227]
s_waitcnt lgkmcnt(0)
s_barrier
v_mfma_f32_16x16x32_bf16 v[16:19], v[144:147], v[160:163], v[16:19]
ds_read_b128 v[48:51], v124 offset:32768
v_mfma_f32_16x16x32_bf16 v[32:35], v[148:151], v[160:163], v[32:35]
ds_read_b128 v[64:67], v126 offset:32768
v_mfma_f32_16x16x32_bf16 v[196:199], v[152:155], v[160:163], v[196:199]
ds_read_b128 v[52:55], v124 offset:33280
v_mfma_f32_16x16x32_bf16 v[212:215], v[156:159], v[160:163], v[212:215]
ds_read_b128 v[56:59], v124 offset:36864
v_mfma_f32_16x16x32_bf16 v[20:23], v[144:147], v[164:167], v[20:23]
ds_read_b128 v[60:63], v124 offset:37376
v_mfma_f32_16x16x32_bf16 v[36:39], v[148:151], v[164:167], v[36:39]
ds_read_b128 v[68:71], v126 offset:34816
v_mfma_f32_16x16x32_bf16 v[200:203], v[152:155], v[164:167], v[200:203]
ds_read_b128 v[72:75], v126 offset:36864
v_mfma_f32_16x16x32_bf16 v[216:219], v[156:159], v[164:167], v[216:219]
ds_read_b128 v[76:79], v126 offset:38912
v_mfma_f32_16x16x32_bf16 v[24:27], v[144:147], v[168:171], v[24:27]
ds_read_b128 v[80:83], v125 offset:32768
v_mfma_f32_16x16x32_bf16 v[40:43], v[148:151], v[168:171], v[40:43]
ds_read_b128 v[96:99], v127 offset:32768
v_mfma_f32_16x16x32_bf16 v[204:207], v[152:155], v[168:171], v[204:207]
ds_read_b128 v[84:87], v125 offset:33280
v_mfma_f32_16x16x32_bf16 v[220:223], v[156:159], v[168:171], v[220:223]
ds_read_b128 v[88:91], v125 offset:36864
v_mfma_f32_16x16x32_bf16 v[28:31], v[144:147], v[172:175], v[28:31]
ds_read_b128 v[92:95], v125 offset:37376
v_mfma_f32_16x16x32_bf16 v[44:47], v[148:151], v[172:175], v[44:47]
ds_read_b128 v[100:103], v127 offset:34816
v_mfma_f32_16x16x32_bf16 v[208:211], v[152:155], v[172:175], v[208:211]
ds_read_b128 v[104:107], v127 offset:36864
v_mfma_f32_16x16x32_bf16 v[224:227], v[156:159], v[172:175], v[224:227]
ds_read_b128 v[108:111], v127 offset:38912
v_mfma_f32_16x16x32_bf16 v[16:19], v[176:179], v[192:195], v[16:19]
v_mfma_f32_16x16x32_bf16 v[32:35], v[180:183], v[192:195], v[32:35]
v_mfma_f32_16x16x32_bf16 v[196:199], v[184:187], v[192:195], v[196:199]
v_mfma_f32_16x16x32_bf16 v[212:215], v[188:191], v[192:195], v[212:215]
v_mfma_f32_16x16x32_bf16 v[20:23], v[176:179], v[228:231], v[20:23]
v_mfma_f32_16x16x32_bf16 v[36:39], v[180:183], v[228:231], v[36:39]
v_mfma_f32_16x16x32_bf16 v[200:203], v[184:187], v[228:231], v[200:203]
v_mfma_f32_16x16x32_bf16 v[216:219], v[188:191], v[228:231], v[216:219]
v_mfma_f32_16x16x32_bf16 v[24:27], v[176:179], v[232:235], v[24:27]
v_mfma_f32_16x16x32_bf16 v[40:43], v[180:183], v[232:235], v[40:43]
v_mfma_f32_16x16x32_bf16 v[204:207], v[184:187], v[232:235], v[204:207]
v_mfma_f32_16x16x32_bf16 v[220:223], v[188:191], v[232:235], v[220:223]
v_mfma_f32_16x16x32_bf16 v[28:31], v[176:179], v[236:239], v[28:31]
v_mfma_f32_16x16x32_bf16 v[44:47], v[180:183], v[236:239], v[44:47]
v_mfma_f32_16x16x32_bf16 v[208:211], v[184:187], v[236:239], v[208:211]
v_mfma_f32_16x16x32_bf16 v[224:227], v[188:191], v[236:239], v[224:227]
s_waitcnt lgkmcnt(0)
s_barrier
v_mfma_f32_16x16x32_bf16 v[16:19], v[48:51], v[64:67], v[16:19]
s_lshl_b32 s76, s3, 13
s_add_u32 s76, s76, 0x18000
v_lshl_add_u32 v10, v1, 4, s76
ds_read_b128 v[160:163], v137 offset:10240
ds_read_b128 v[164:167], v137 offset:10752
ds_read_b128 v[172:175], v139 offset:7680
ds_read_b128 v[168:171], v137 offset:512
ds_read_b128 v[176:179], v137 offset:11776
ds_read_b128 v[188:191], v138 offset:0
ds_read_b128 v[180:183], v137 offset:11264
ds_read_b128 v[184:187], v136 offset:8192
v_mfma_f32_16x16x32_bf16 v[32:35], v[52:55], v[64:67], v[32:35]
v_mfma_f32_16x16x32_bf16 v[196:199], v[56:59], v[64:67], v[196:199]
v_mfma_f32_16x16x32_bf16 v[212:215], v[60:63], v[64:67], v[212:215]
v_mfma_f32_16x16x32_bf16 v[20:23], v[48:51], v[68:71], v[20:23]
v_mfma_f32_16x16x32_bf16 v[36:39], v[52:55], v[68:71], v[36:39]
v_mfma_f32_16x16x32_bf16 v[200:203], v[56:59], v[68:71], v[200:203]
v_mfma_f32_16x16x32_bf16 v[216:219], v[60:63], v[68:71], v[216:219]
v_mfma_f32_16x16x32_bf16 v[24:27], v[48:51], v[72:75], v[24:27]
v_mfma_f32_16x16x32_bf16 v[40:43], v[52:55], v[72:75], v[40:43]
v_mfma_f32_16x16x32_bf16 v[204:207], v[56:59], v[72:75], v[204:207]
v_mfma_f32_16x16x32_bf16 v[220:223], v[60:63], v[72:75], v[220:223]
v_mfma_f32_16x16x32_bf16 v[28:31], v[48:51], v[76:79], v[28:31]
v_mfma_f32_16x16x32_bf16 v[44:47], v[52:55], v[76:79], v[44:47]
v_mfma_f32_16x16x32_bf16 v[208:211], v[56:59], v[76:79], v[208:211]
v_mfma_f32_16x16x32_bf16 v[224:227], v[60:63], v[76:79], v[224:227]
v_mfma_f32_16x16x32_bf16 v[16:19], v[80:83], v[96:99], v[16:19]
v_mfma_f32_16x16x32_bf16 v[32:35], v[84:87], v[96:99], v[32:35]
v_mfma_f32_16x16x32_bf16 v[196:199], v[88:91], v[96:99], v[196:199]
v_mfma_f32_16x16x32_bf16 v[212:215], v[92:95], v[96:99], v[212:215]
v_mfma_f32_16x16x32_bf16 v[20:23], v[80:83], v[100:103], v[20:23]
v_mfma_f32_16x16x32_bf16 v[36:39], v[84:87], v[100:103], v[36:39]
v_mfma_f32_16x16x32_bf16 v[200:203], v[88:91], v[100:103], v[200:203]
v_mfma_f32_16x16x32_bf16 v[216:219], v[92:95], v[100:103], v[216:219]
v_mfma_f32_16x16x32_bf16 v[24:27], v[80:83], v[104:107], v[24:27]
v_mfma_f32_16x16x32_bf16 v[40:43], v[84:87], v[104:107], v[40:43]
v_mfma_f32_16x16x32_bf16 v[204:207], v[88:91], v[104:107], v[204:207]
v_mfma_f32_16x16x32_bf16 v[220:223], v[92:95], v[104:107], v[220:223]
v_mfma_f32_16x16x32_bf16 v[28:31], v[80:83], v[108:111], v[28:31]
v_mfma_f32_16x16x32_bf16 v[44:47], v[84:87], v[108:111], v[44:47]
v_mfma_f32_16x16x32_bf16 v[208:211], v[88:91], v[108:111], v[208:211]
v_mfma_f32_16x16x32_bf16 v[224:227], v[92:95], v[108:111], v[224:227]
ds_write_b128 v10, v[196:199] offset:0
ds_write_b128 v10, v[200:203] offset:1024
s_nop 0
ds_write_b128 v10, v[204:207] offset:2048
s_nop 2
ds_write_b128 v10, v[208:211] offset:3072
ds_write_b128 v10, v[212:215] offset:4096
ds_write_b128 v10, v[216:219] offset:5120
ds_write_b128 v10, v[220:223] offset:6144
ds_write_b128 v10, v[224:227] offset:7168
s_waitcnt lgkmcnt(0) vmcnt(0)
s_barrier
L_A_join:
v_cmp_ne_u32 vcc, 1, v113
s_cbranch_vccz L_A_clean
s_mov_b32 s77, 0x40000
L_cc_9:
global_load_dword v113, v112, s[46:47] offset:64 sc1
s_waitcnt vmcnt(0)
v_cmp_ne_u32 vcc, 1, v113
s_cbranch_vccz L_ccd_10
s_sleep 4
s_sub_u32 s77, s77, 1
s_cmp_lg_u32 s77, 0
s_cbranch_scc1 L_cc_9
L_ccd_10:
L_A_clean:
v_pk_fma_f32 v[56:57], v[164:165], v[16:17], v[18:19] op_sel:[0,0,0] op_sel_hi:[0,1,1]
v_pk_fma_f32 v[58:59], v[164:165], v[16:17], v[26:27] op_sel:[1,0,0] op_sel_hi:[1,1,1]
v_pk_fma_f32 v[60:61], v[166:167], v[20:21], v[22:23] op_sel:[0,0,0] op_sel_hi:[0,1,1]
v_pk_fma_f32 v[62:63], v[166:167], v[20:21], v[30:31] op_sel:[1,0,0] op_sel_hi:[1,1,1]
v_pk_fma_f32 v[56:57], v[164:165], v[24:25], v[56:57] op_sel:[1,0,0] op_sel_hi:[1,1,1] neg_lo:[1,0,0] neg_hi:[1,0,0]
v_pk_fma_f32 v[58:59], v[164:165], v[24:25], v[58:59] op_sel:[0,0,0] op_sel_hi:[0,1,1]
v_pk_fma_f32 v[60:61], v[166:167], v[28:29], v[60:61] op_sel:[1,0,0] op_sel_hi:[1,1,1] neg_lo:[1,0,0] neg_hi:[1,0,0]
v_pk_fma_f32 v[62:63], v[166:167], v[28:29], v[62:63] op_sel:[0,0,0] op_sel_hi:[0,1,1]
v_pk_fma_f32 v[48:49], v[164:165], v[56:57], v[32:33] op_sel:[0,0,0] op_sel_hi:[0,1,1]
v_pk_fma_f32 v[50:51], v[164:165], v[56:57], v[40:41] op_sel:[1,0,0] op_sel_hi:[1,1,1]
v_pk_fma_f32 v[52:53], v[166:167], v[60:61], v[36:37] op_sel:[0,0,0] op_sel_hi:[0,1,1]
v_pk_fma_f32 v[54:55], v[166:167], v[60:61], v[44:45] op_sel:[1,0,0] op_sel_hi:[1,1,1]
v_pk_fma_f32 v[48:49], v[164:165], v[58:59], v[48:49] op_sel:[1,0,0] op_sel_hi:[1,1,1] neg_lo:[1,0,0] neg_hi:[1,0,0]
v_pk_fma_f32 v[50:51], v[164:165], v[58:59], v[50:51] op_sel:[0,0,0] op_sel_hi:[0,1,1]
v_pk_fma_f32 v[52:53], v[166:167], v[62:63], v[52:53] op_sel:[1,0,0] op_sel_hi:[1,1,1] neg_lo:[1,0,0] neg_hi:[1,0,0]
v_pk_fma_f32 v[54:55], v[166:167], v[62:63], v[54:55] op_sel:[0,0,0] op_sel_hi:[0,1,1]
v_pk_fma_f32 v[56:57], v[164:165], v[48:49], v[34:35] op_sel:[0,0,0] op_sel_hi:[0,1,1]
v_pk_fma_f32 v[58:59], v[164:165], v[48:49], v[42:43] op_sel:[1,0,0] op_sel_hi:[1,1,1]
v_pk_fma_f32 v[60:61], v[166:167], v[52:53], v[38:39] op_sel:[0,0,0] op_sel_hi:[0,1,1]
v_pk_fma_f32 v[62:63], v[166:167], v[52:53], v[46:47] op_sel:[1,0,0] op_sel_hi:[1,1,1]
v_pk_fma_f32 v[56:57], v[164:165], v[50:51], v[56:57] op_sel:[1,0,0] op_sel_hi:[1,1,1] neg_lo:[1,0,0] neg_hi:[1,0,0]
v_pk_fma_f32 v[58:59], v[164:165], v[50:51], v[58:59] op_sel:[0,0,0] op_sel_hi:[0,1,1]
v_pk_fma_f32 v[60:61], v[166:167], v[54:55], v[60:61] op_sel:[1,0,0] op_sel_hi:[1,1,1] neg_lo:[1,0,0] neg_hi:[1,0,0]
v_pk_fma_f32 v[62:63], v[166:167], v[54:55], v[62:63] op_sel:[0,0,0] op_sel_hi:[0,1,1]
v_fma_f32 v64, v56, v160, v57
v_fma_f32 v65, v56, v161, v59
v_fma_f32 v64, -v58, v161, v64
v_fma_f32 v65, v58, v160, v65
v_fma_f32 v66, v60, v162, v61
v_fma_f32 v67, v60, v163, v63
v_fma_f32 v66, -v62, v163, v66
v_fma_f32 v67, v62, v162, v67
v_pk_mul_f32 v[68:69], v[64:65], v[172:173] op_sel:[0,0] op_sel_hi:[1,0]
v_pk_fma_f32 v[68:69], v[64:65], v[172:173], v[68:69] op_sel:[1,1,0] op_sel_hi:[0,1,1] neg_lo:[0,1,0]
v_pk_mul_f32 v[70:71], v[66:67], v[174:175] op_sel:[0,0] op_sel_hi:[1,0]
v_pk_fma_f32 v[70:71], v[66:67], v[174:175], v[70:71] op_sel:[1,1,0] op_sel_hi:[0,1,1] neg_lo:[0,1,0]
ds_write_b128 v128, v[64:67]
v_mov_b32 v72, v68
v_mov_b32 v73, v69
v_mov_b32 v74, v70
v_mov_b32 v75, v71
v_permlane16_swap_b32 v72, v68
v_permlane16_swap_b32 v73, v69
v_permlane16_swap_b32 v74, v70
v_permlane16_swap_b32 v75, v71
v_add_f32 v68, v68, v72
v_add_f32 v69, v69, v73
v_add_f32 v70, v70, v74
v_add_f32 v71, v71, v75
v_mov_b32 v72, v68
v_mov_b32 v73, v69
v_mov_b32 v74, v70
v_mov_b32 v75, v71
v_permlane32_swap_b32 v72, v68
v_permlane32_swap_b32 v73, v69
v_permlane32_swap_b32 v74, v70
v_permlane32_swap_b32 v75, v71
v_add_f32 v68, v68, v72
v_add_f32 v69, v69, v73
v_add_f32 v70, v70, v74
v_add_f32 v71, v71, v75
s_mov_b64 exec, 0xffff
ds_write_b128 v130, v[68:71]
s_mov_b64 exec, -1
s_lshl_b32 s76, s7, 12
s_lshl_b32 s77, s6, 8
s_add_u32 s79, s76, s77
s_waitcnt lgkmcnt(0)
s_barrier
s_cmp_lg_u32 s34, 0
s_cbranch_scc1 L_A_nopub
ds_read_b128 v[68:71], v129
ds_read_b128 v[72:75], v129 offset:256
ds_read_b128 v[76:79], v129 offset:512
ds_read_b128 v[80:83], v129 offset:768
s_waitcnt lgkmcnt(0)
v_pk_add_f32 v[68:69], v[68:69], v[72:73]
v_pk_add_f32 v[70:71], v[70:71], v[74:75]
v_pk_add_f32 v[76:77], v[76:77], v[80:81]
v_pk_add_f32 v[78:79], v[78:79], v[82:83]
v_pk_add_f32 v[68:69], v[68:69], v[76:77]
v_pk_add_f32 v[70:71], v[70:71], v[78:79]
v_min_u32 v68, -2, v68
v_min_u32 v69, -2, v69
v_min_u32 v70, -2, v70
v_min_u32 v71, -2, v71
s_mov_b64 exec, 0xffff
buffer_store_dwordx4 v[68:71], v131, s[68:71], s79 offen sc1
s_mov_b64 exec, -1
L_A_nopub:
ds_read_b128 v[196:199], v137 offset:12288
ds_read_b128 v[200:203], v137 offset:12800
ds_read_b128 v[204:207], v137 offset:13312
ds_read_b128 v[208:211], v137 offset:13824
ds_read_b128 v[212:215], v137 offset:14336
ds_read_b128 v[216:219], v137 offset:14848
ds_read_b128 v[220:223], v137 offset:15360
ds_read_b128 v[224:227], v137 offset:15872
s_cmp_lt_u32 s3, 4
s_cbranch_scc1 L_A_noc
v_xor_b32 v9, 0, v8
v_add_u32 v9, s36, v9
v_and_b32 v9, 0x3ff, v9
s_add_u32 m0, s37, 98304
s_add_u32 s76, s38, 32768
buffer_load_dwordx4 v9, s[64:67], s76 offen lds
v_xor_b32 v9, 16, v8
v_add_u32 v9, s36, v9
v_and_b32 v9, 0x3ff, v9
s_add_u32 m0, s37, 99328
s_add_u32 s76, s38, 33792
buffer_load_dwordx4 v9, s[64:67], s76 offen lds
v_xor_b32 v9, 32, v8
v_add_u32 v9, s36, v9
v_and_b32 v9, 0x3ff, v9
s_add_u32 m0, s37, 100352
s_add_u32 s76, s38, 34816
buffer_load_dwordx4 v9, s[64:67], s76 offen lds
v_xor_b32 v9, 48, v8
v_add_u32 v9, s36, v9
v_and_b32 v9, 0x3ff, v9
s_add_u32 m0, s37, 101376
s_add_u32 s76, s38, 35840
buffer_load_dwordx4 v9, s[64:67], s76 offen lds
v_xor_b32 v9, 64, v8
v_add_u32 v9, s36, v9
v_and_b32 v9, 0x3ff, v9
s_add_u32 m0, s37, 102400
s_add_u32 s76, s38, 36864
buffer_load_dwordx4 v9, s[64:67], s76 offen lds
v_xor_b32 v9, 80, v8
v_add_u32 v9, s36, v9
v_and_b32 v9, 0x3ff, v9
s_add_u32 m0, s37, 103424
s_add_u32 s76, s38, 37888
buffer_load_dwordx4 v9, s[64:67], s76 offen lds
v_xor_b32 v9, 96, v8
v_add_u32 v9, s36, v9
v_and_b32 v9, 0x3ff, v9
s_add_u32 m0, s37, 104448
s_add_u32 s76, s38, 38912
buffer_load_dwordx4 v9, s[64:67], s76 offen lds
v_xor_b32 v9, 112, v8
v_add_u32 v9, s36, v9
v_and_b32 v9, 0x3ff, v9
s_add_u32 m0, s37, 105472
s_add_u32 s76, s38, 39936
buffer_load_dwordx4 v9, s[64:67], s76 offen lds
L_A_noc:
v_pk_mul_f32 v[96:97], v[16:17], v[176:177] op_sel:[0,0] op_sel_hi:[0,1]
v_pk_mul_f32 v[98:99], v[20:21], v[178:179] op_sel:[0,0] op_sel_hi:[0,1]
v_pk_fma_f32 v[96:97], v[176:177], v[24:25], v[96:97] op_sel:[1,0,0] op_sel_hi:[0,0,1] neg_lo:[1,0,0]
v_pk_fma_f32 v[98:99], v[178:179], v[28:29], v[98:99] op_sel:[1,0,0] op_sel_hi:[0,0,1] neg_lo:[1,0,0]
v_pk_mul_f32 v[100:101], v[16:17], v[176:177] op_sel:[1,0] op_sel_hi:[1,1]
v_pk_mul_f32 v[102:103], v[20:21], v[178:179] op_sel:[1,0] op_sel_hi:[1,1]
v_pk_fma_f32 v[100:101], v[176:177], v[24:25], v[100:101] op_sel:[1,1,0] op_sel_hi:[0,1,1] neg_lo:[1,0,0]
v_pk_fma_f32 v[102:103], v[178:179], v[28:29], v[102:103] op_sel:[1,1,0] op_sel_hi:[0,1,1] neg_lo:[1,0,0]
v_pk_mul_f32 v[104:105], v[18:19], v[176:177] op_sel:[0,0] op_sel_hi:[0,1]
v_pk_mul_f32 v[106:107], v[22:23], v[178:179] op_sel:[0,0] op_sel_hi:[0,1]
v_pk_fma_f32 v[104:105], v[176:177], v[26:27], v[104:105] op_sel:[1,0,0] op_sel_hi:[0,0,1] neg_lo:[1,0,0]
v_pk_fma_f32 v[106:107], v[178:179], v[30:31], v[106:107] op_sel:[1,0,0] op_sel_hi:[0,0,1] neg_lo:[1,0,0]
v_pk_mul_f32 v[108:109], v[18:19], v[176:177] op_sel:[1,0] op_sel_hi:[1,1]
v_pk_mul_f32 v[110:111], v[22:23], v[178:179] op_sel:[1,0] op_sel_hi:[1,1]
v_pk_fma_f32 v[108:109], v[176:177], v[26:27], v[108:109] op_sel:[1,1,0] op_sel_hi:[0,1,1] neg_lo:[1,0,0]
v_pk_fma_f32 v[110:111], v[178:179], v[30:31], v[110:111] op_sel:[1,1,0] op_sel_hi:[0,1,1] neg_lo:[1,0,0]
v_pk_mul_f32 v[112:113], v[32:33], v[176:177] op_sel:[0,0] op_sel_hi:[0,1]
v_pk_mul_f32 v[114:115], v[36:37], v[178:179] op_sel:[0,0] op_sel_hi:[0,1]
v_pk_fma_f32 v[112:113], v[176:177], v[40:41], v[112:113] op_sel:[1,0,0] op_sel_hi:[0,0,1] neg_lo:[1,0,0]
v_pk_fma_f32 v[114:115], v[178:179], v[44:45], v[114:115] op_sel:[1,0,0] op_sel_hi:[0,0,1] neg_lo:[1,0,0]
v_pk_mul_f32 v[116:117], v[32:33], v[176:177] op_sel:[1,0] op_sel_hi:[1,1]
v_pk_mul_f32 v[118:119], v[36:37], v[178:179] op_sel:[1,0] op_sel_hi:[1,1]
v_pk_fma_f32 v[116:117], v[176:177], v[40:41], v[116:117] op_sel:[1,1,0] op_sel_hi:[0,1,1] neg_lo:[1,0,0]
v_pk_fma_f32 v[118:119], v[178:179], v[44:45], v[118:119] op_sel:[1,1,0] op_sel_hi:[0,1,1] neg_lo:[1,0,0]
v_pk_mul_f32 v[120:121], v[34:35], v[176:177] op_sel:[0,0] op_sel_hi:[0,1]
v_pk_mul_f32 v[122:123], v[38:39], v[178:179] op_sel:[0,0] op_sel_hi:[0,1]
v_pk_fma_f32 v[120:121], v[176:177], v[42:43], v[120:121] op_sel:[1,0,0] op_sel_hi:[0,0,1] neg_lo:[1,0,0]
v_pk_fma_f32 v[122:123], v[178:179], v[46:47], v[122:123] op_sel:[1,0,0] op_sel_hi:[0,0,1] neg_lo:[1,0,0]
v_pk_mul_f32 v[124:125], v[34:35], v[176:177] op_sel:[1,0] op_sel_hi:[1,1]
v_pk_mul_f32 v[126:127], v[38:39], v[178:179] op_sel:[1,0] op_sel_hi:[1,1]
v_pk_fma_f32 v[124:125], v[176:177], v[42:43], v[124:125] op_sel:[1,1,0] op_sel_hi:[0,1,1] neg_lo:[1,0,0]
v_pk_fma_f32 v[126:127], v[178:179], v[46:47], v[126:127] op_sel:[1,1,0] op_sel_hi:[0,1,1] neg_lo:[1,0,0]
v_mov_b32 v64, 0
v_mov_b32 v65, 0
v_mov_b32 v66, 0
v_mov_b32 v67, 0
s_mov_b32 s77, s34
s_cmp_eq_u32 s77, 0
s_cbranch_scc1 L_A_pf2
L_A_pf1:
ds_read_b128 v[68:71], v132
ds_read_b128 v[72:75], v132 offset:256
ds_read_b128 v[76:79], v132 offset:512
ds_read_b128 v[80:83], v132 offset:768
s_waitcnt lgkmcnt(0)
v_add_u32 v132, 1024, v132
v_pk_fma_f32 v[68:69], v[64:65], v[168:169], v[68:69] op_sel:[0,0,0] op_sel_hi:[1,0,1]
v_pk_fma_f32 v[70:71], v[66:67], v[170:171], v[70:71] op_sel:[0,0,0] op_sel_hi:[1,0,1]
v_pk_fma_f32 v[68:69], v[64:65], v[168:169], v[68:69] op_sel:[1,1,0] op_sel_hi:[0,1,1] neg_lo:[0,1,0]
v_pk_fma_f32 v[70:71], v[66:67], v[170:171], v[70:71] op_sel:[1,1,0] op_sel_hi:[0,1,1] neg_lo:[0,1,0]
v_pk_fma_f32 v[72:73], v[68:69], v[168:169], v[72:73] op_sel:[0,0,0] op_sel_hi:[1,0,1]
v_pk_fma_f32 v[74:75], v[70:71], v[170:171], v[74:75] op_sel:[0,0,0] op_sel_hi:[1,0,1]
v_pk_fma_f32 v[72:73], v[68:69], v[168:169], v[72:73] op_sel:[1,1,0] op_sel_hi:[0,1,1] neg_lo:[0,1,0]
v_pk_fma_f32 v[74:75], v[70:71], v[170:171], v[74:75] op_sel:[1,1,0] op_sel_hi:[0,1,1] neg_lo:[0,1,0]
v_pk_fma_f32 v[76:77], v[72:73], v[168:169], v[76:77] op_sel:[0,0,0] op_sel_hi:[1,0,1]
v_pk_fma_f32 v[78:79], v[74:75], v[170:171], v[78:79] op_sel:[0,0,0] op_sel_hi:[1,0,1]
v_pk_fma_f32 v[76:77], v[72:73], v[168:169], v[76:77] op_sel:[1,1,0] op_sel_hi:[0,1,1] neg_lo:[0,1,0]
v_pk_fma_f32 v[78:79], v[74:75], v[170:171], v[78:79] op_sel:[1,1,0] op_sel_hi:[0,1,1] neg_lo:[0,1,0]
v_pk_fma_f32 v[80:81], v[76:77], v[168:169], v[80:81] op_sel:[0,0,0] op_sel_hi:[1,0,1]
v_pk_fma_f32 v[82:83], v[78:79], v[170:171], v[82:83] op_sel:[0,0,0] op_sel_hi:[1,0,1]
v_pk_fma_f32 v[80:81], v[76:77], v[168:169], v[80:81] op_sel:[1,1,0] op_sel_hi:[0,1,1] neg_lo:[0,1,0]
v_pk_fma_f32 v[82:83], v[78:79], v[170:171], v[82:83] op_sel:[1,1,0] op_sel_hi:[0,1,1] neg_lo:[0,1,0]
v_mov_b32 v64, v80
v_mov_b32 v65, v81
v_mov_b32 v66, v82
v_mov_b32 v67, v83
s_sub_u32 s77, s77, 1
s_cmp_lg_u32 s77, 0
s_cbranch_scc1 L_A_pf1
L_A_pf2:
ds_read_b128 v[68:71], v132
ds_read_b128 v[72:75], v132 offset:256
ds_read_b128 v[76:79], v132 offset:512
s_waitcnt lgkmcnt(0)
v_pk_fma_f32 v[68:69], v[64:65], v[168:169], v[68:69] op_sel:[0,0,0] op_sel_hi:[1,0,1]
v_pk_fma_f32 v[70:71], v[66:67], v[170:171], v[70:71] op_sel:[0,0,0] op_sel_hi:[1,0,1]
v_pk_fma_f32 v[68:69], v[64:65], v[168:169], v[68:69] op_sel:[1,1,0] op_sel_hi:[0,1,1] neg_lo:[0,1,0]
v_pk_fma_f32 v[70:71], v[66:67], v[170:171], v[70:71] op_sel:[1,1,0] op_sel_hi:[0,1,1] neg_lo:[0,1,0]
v_pk_fma_f32 v[72:73], v[68:69], v[168:169], v[72:73] op_sel:[0,0,0] op_sel_hi:[1,0,1]
v_pk_fma_f32 v[74:75], v[70:71], v[170:171], v[74:75] op_sel:[0,0,0] op_sel_hi:[1,0,1]
v_pk_fma_f32 v[72:73], v[68:69], v[168:169], v[72:73] op_sel:[1,1,0] op_sel_hi:[0,1,1] neg_lo:[0,1,0]
v_pk_fma_f32 v[74:75], v[70:71], v[170:171], v[74:75] op_sel:[1,1,0] op_sel_hi:[0,1,1] neg_lo:[0,1,0]
v_pk_fma_f32 v[76:77], v[72:73], v[168:169], v[76:77] op_sel:[0,0,0] op_sel_hi:[1,0,1]
v_pk_fma_f32 v[78:79], v[74:75], v[170:171], v[78:79] op_sel:[0,0,0] op_sel_hi:[1,0,1]
v_pk_fma_f32 v[76:77], v[72:73], v[168:169], v[76:77] op_sel:[1,1,0] op_sel_hi:[0,1,1] neg_lo:[0,1,0]
v_pk_fma_f32 v[78:79], v[74:75], v[170:171], v[78:79] op_sel:[1,1,0] op_sel_hi:[0,1,1] neg_lo:[0,1,0]
v_cmp_eq_u32 vcc, 1, v3
s_nop 1
v_cndmask_b32 v64, v64, v68, vcc
v_cndmask_b32 v65, v65, v69, vcc
v_cndmask_b32 v66, v66, v70, vcc
v_cndmask_b32 v67, v67, v71, vcc
v_cmp_eq_u32 vcc, 2, v3
s_nop 1
v_cndmask_b32 v64, v64, v72, vcc
v_cndmask_b32 v65, v65, v73, vcc
v_cndmask_b32 v66, v66, v74, vcc
v_cndmask_b32 v67, v67, v75, vcc
v_cmp_eq_u32 vcc, 3, v3
s_nop 1
v_cndmask_b32 v64, v64, v76, vcc
v_cndmask_b32 v65, v65, v77, vcc
v_cndmask_b32 v66, v66, v78, vcc
v_cndmask_b32 v67, v67, v79, vcc
v_pk_mul_f32 v[92:93], v[64:65], v[176:177] op_sel:[0,0] op_sel_hi:[1,0]
v_pk_fma_f32 v[92:93], v[64:65], v[176:177], v[92:93] op_sel:[1,1,0] op_sel_hi:[0,1,1] neg_lo:[0,1,0]
v_pk_mul_f32 v[94:95], v[66:67], v[178:179] op_sel:[0,0] op_sel_hi:[1,0]
v_pk_fma_f32 v[94:95], v[66:67], v[178:179], v[94:95] op_sel:[1,1,0] op_sel_hi:[0,1,1] neg_lo:[0,1,0]
v_pk_fma_f32 v[96:97], v[92:93], v[160:161], v[96:97] op_sel:[0,0,0] op_sel_hi:[1,0,1]
v_pk_fma_f32 v[98:99], v[94:95], v[162:163], v[98:99] op_sel:[0,0,0] op_sel_hi:[1,0,1]
v_pk_fma_f32 v[96:97], v[92:93], v[160:161], v[96:97] op_sel:[1,1,0] op_sel_hi:[0,1,1] neg_lo:[0,1,0]
v_pk_fma_f32 v[98:99], v[94:95], v[162:163], v[98:99] op_sel:[1,1,0] op_sel_hi:[0,1,1] neg_lo:[0,1,0]
v_pk_fma_f32 v[100:101], v[96:97], v[160:161], v[100:101] op_sel:[0,0,0] op_sel_hi:[1,0,1]
v_pk_fma_f32 v[102:103], v[98:99], v[162:163], v[102:103] op_sel:[0,0,0] op_sel_hi:[1,0,1]
v_pk_fma_f32 v[100:101], v[96:97], v[160:161], v[100:101] op_sel:[1,1,0] op_sel_hi:[0,1,1] neg_lo:[0,1,0]
v_pk_fma_f32 v[102:103], v[98:99], v[162:163], v[102:103] op_sel:[1,1,0] op_sel_hi:[0,1,1] neg_lo:[0,1,0]
v_pk_fma_f32 v[104:105], v[100:101], v[160:161], v[104:105] op_sel:[0,0,0] op_sel_hi:[1,0,1]
v_pk_fma_f32 v[106:107], v[102:103], v[162:163], v[106:107] op_sel:[0,0,0] op_sel_hi:[1,0,1]
v_pk_fma_f32 v[104:105], v[100:101], v[160:161], v[104:105] op_sel:[1,1,0] op_sel_hi:[0,1,1] neg_lo:[0,1,0]
v_pk_fma_f32 v[106:107], v[102:103], v[162:163], v[106:107] op_sel:[1,1,0] op_sel_hi:[0,1,1] neg_lo:[0,1,0]
v_pk_fma_f32 v[108:109], v[104:105], v[160:161], v[108:109] op_sel:[0,0,0] op_sel_hi:[1,0,1]
v_pk_fma_f32 v[110:111], v[106:107], v[162:163], v[110:111] op_sel:[0,0,0] op_sel_hi:[1,0,1]
v_pk_fma_f32 v[108:109], v[104:105], v[160:161], v[108:109] op_sel:[1,1,0] op_sel_hi:[0,1,1] neg_lo:[0,1,0]
v_pk_fma_f32 v[110:111], v[106:107], v[162:163], v[110:111] op_sel:[1,1,0] op_sel_hi:[0,1,1] neg_lo:[0,1,0]
v_pk_fma_f32 v[112:113], v[108:109], v[160:161], v[112:113] op_sel:[0,0,0] op_sel_hi:[1,0,1]
v_pk_fma_f32 v[114:115], v[110:111], v[162:163], v[114:115] op_sel:[0,0,0] op_sel_hi:[1,0,1]
v_pk_fma_f32 v[112:113], v[108:109], v[160:161], v[112:113] op_sel:[1,1,0] op_sel_hi:[0,1,1] neg_lo:[0,1,0]
v_pk_fma_f32 v[114:115], v[110:111], v[162:163], v[114:115] op_sel:[1,1,0] op_sel_hi:[0,1,1] neg_lo:[0,1,0]
v_pk_fma_f32 v[116:117], v[112:113], v[160:161], v[116:117] op_sel:[0,0,0] op_sel_hi:[1,0,1]
v_pk_fma_f32 v[118:119], v[114:115], v[162:163], v[118:119] op_sel:[0,0,0] op_sel_hi:[1,0,1]
v_pk_fma_f32 v[116:117], v[112:113], v[160:161], v[116:117] op_sel:[1,1,0] op_sel_hi:[0,1,1] neg_lo:[0,1,0]
v_pk_fma_f32 v[118:119], v[114:115], v[162:163], v[118:119] op_sel:[1,1,0] op_sel_hi:[0,1,1] neg_lo:[0,1,0]
v_pk_fma_f32 v[120:121], v[116:117], v[160:161], v[120:121] op_sel:[0,0,0] op_sel_hi:[1,0,1]
v_pk_fma_f32 v[122:123], v[118:119], v[162:163], v[122:123] op_sel:[0,0,0] op_sel_hi:[1,0,1]
v_pk_fma_f32 v[120:121], v[116:117], v[160:161], v[120:121] op_sel:[1,1,0] op_sel_hi:[0,1,1] neg_lo:[0,1,0]
v_pk_fma_f32 v[122:123], v[118:119], v[162:163], v[122:123] op_sel:[1,1,0] op_sel_hi:[0,1,1] neg_lo:[0,1,0]
v_pk_fma_f32 v[124:125], v[120:121], v[160:161], v[124:125] op_sel:[0,0,0] op_sel_hi:[1,0,1]
v_pk_fma_f32 v[126:127], v[122:123], v[162:163], v[126:127] op_sel:[0,0,0] op_sel_hi:[1,0,1]
v_pk_fma_f32 v[124:125], v[120:121], v[160:161], v[124:125] op_sel:[1,1,0] op_sel_hi:[0,1,1] neg_lo:[0,1,0]
v_pk_fma_f32 v[126:127], v[122:123], v[162:163], v[126:127] op_sel:[1,1,0] op_sel_hi:[0,1,1] neg_lo:[0,1,0]
s_lshl_b32 s76, s6, 3
s_lshl_b32 s77, s34, 1
s_add_u32 s76, s76, s77
s_lshl_b32 s76, s76, 5
s_add_u32 s76, s76, s7
s_lshl_b32 s76, s76, 10
s_add_u32 s80, s76, 1048576
s_add_u32 s81, s80, 16384
s_lshl_b32 s79, s6, 10
s_lshl_b32 s76, s34, 4
s_add_u32 s76, s76, s7
s_lshl_b32 s76, s76, 2
s_add_u32 s79, s79, s76
s_add_u32 s79, s79, 65536
s_cmp_eq_u32 s6, 0
s_cbranch_scc1 L_A_cw
s_cmp_lg_u32 s34, 0
s_cbranch_scc1 L_A_cw
v_mov_b32 v72, 0
v_mov_b32 v73, 0
v_mov_b32 v74, 0
v_mov_b32 v75, 0
s_lshl_b32 s78, s7, 12
s_mov_b32 s77, 0x40000
L_A_cp:
buffer_load_dwordx4 v[144:147], v140, s[68:71], s78 offen sc1
buffer_load_dwordx4 v[148:151], v141, s[68:71], s78 offen sc1
buffer_load_dwordx4 v[152:155], v142, s[68:71], s78 offen sc1
buffer_load_dwordx4 v[156:159], v143, s[68:71], s78 offen sc1
v_mov_b32 v95, 0
v_add_u32 v94, 0, v3
v_cmp_gt_u32 vcc, s6, v94
s_waitcnt vmcnt(3)
s_nop 0
v_cndmask_b32 v144, 0, v144, vcc
v_cndmask_b32 v145, 0, v145, vcc
v_cndmask_b32 v146, 0, v146, vcc
v_cndmask_b32 v147, 0, v147, vcc
v_max3_u32 v95, v95, v144, v145
v_max3_u32 v95, v95, v146, v147
v_add_u32 v94, 4, v3
v_cmp_gt_u32 vcc, s6, v94
s_waitcnt vmcnt(2)
s_nop 0
v_cndmask_b32 v148, 0, v148, vcc
v_cndmask_b32 v149, 0, v149, vcc
v_cndmask_b32 v150, 0, v150, vcc
v_cndmask_b32 v151, 0, v151, vcc
v_max3_u32 v95, v95, v148, v149
v_max3_u32 v95, v95, v150, v151
v_add_u32 v94, 8, v3
v_cmp_gt_u32 vcc, s6, v94
s_waitcnt vmcnt(1)
s_nop 0
v_cndmask_b32 v152, 0, v152, vcc
v_cndmask_b32 v153, 0, v153, vcc
v_cndmask_b32 v154, 0, v154, vcc
v_cndmask_b32 v155, 0, v155, vcc
v_max3_u32 v95, v95, v152, v153
v_max3_u32 v95, v95, v154, v155
v_add_u32 v94, 12, v3
v_cmp_gt_u32 vcc, s6, v94
s_waitcnt vmcnt(0)
s_nop 0
v_cndmask_b32 v156, 0, v156, vcc
v_cndmask_b32 v157, 0, v157, vcc
v_cndmask_b32 v158, 0, v158, vcc
v_cndmask_b32 v159, 0, v159, vcc
v_max3_u32 v95, v95, v156, v157
v_max3_u32 v95, v95, v158, v159
v_cmp_eq_u32 vcc, -1, v95
s_cbranch_vccz L_A_cpd
s_sleep 1
s_sub_u32 s77, s77, 1
s_cmp_lg_u32 s77, 0
s_cbranch_scc1 L_A_cp
L_A_cpd:
v_pk_fma_f32 v[152:153], v[156:157], v[180:181], v[152:153] op_sel:[0,0,0] op_sel_hi:[1,0,1]
v_pk_fma_f32 v[154:155], v[158:159], v[182:183], v[154:155] op_sel:[0,0,0] op_sel_hi:[1,0,1]
v_pk_fma_f32 v[152:153], v[156:157], v[180:181], v[152:153] op_sel:[1,1,0] op_sel_hi:[0,1,1] neg_lo:[0,1,0]
v_pk_fma_f32 v[154:155], v[158:159], v[182:183], v[154:155] op_sel:[1,1,0] op_sel_hi:[0,1,1] neg_lo:[0,1,0]
v_pk_fma_f32 v[148:149], v[152:153], v[180:181], v[148:149] op_sel:[0,0,0] op_sel_hi:[1,0,1]
v_pk_fma_f32 v[150:151], v[154:155], v[182:183], v[150:151] op_sel:[0,0,0] op_sel_hi:[1,0,1]
v_pk_fma_f32 v[148:149], v[152:153], v[180:181], v[148:149] op_sel:[1,1,0] op_sel_hi:[0,1,1] neg_lo:[0,1,0]
v_pk_fma_f32 v[150:151], v[154:155], v[182:183], v[150:151] op_sel:[1,1,0] op_sel_hi:[0,1,1] neg_lo:[0,1,0]
v_pk_fma_f32 v[144:145], v[148:149], v[180:181], v[144:145] op_sel:[0,0,0] op_sel_hi:[1,0,1]
v_pk_fma_f32 v[146:147], v[150:151], v[182:183], v[146:147] op_sel:[0,0,0] op_sel_hi:[1,0,1]
v_pk_fma_f32 v[144:145], v[148:149], v[180:181], v[144:145] op_sel:[1,1,0] op_sel_hi:[0,1,1] neg_lo:[0,1,0]
v_pk_fma_f32 v[146:147], v[150:151], v[182:183], v[146:147] op_sel:[1,1,0] op_sel_hi:[0,1,1] neg_lo:[0,1,0]
v_pk_fma_f32 v[72:73], v[144:145], v[184:185], v[72:73] op_sel:[0,0,0] op_sel_hi:[1,0,1]
v_pk_fma_f32 v[74:75], v[146:147], v[186:187], v[74:75] op_sel:[0,0,0] op_sel_hi:[1,0,1]
v_pk_fma_f32 v[72:73], v[144:145], v[184:185], v[72:73] op_sel:[1,1,0] op_sel_hi:[0,1,1] neg_lo:[0,1,0]
v_pk_fma_f32 v[74:75], v[146:147], v[186:187], v[74:75] op_sel:[1,1,0] op_sel_hi:[0,1,1] neg_lo:[0,1,0]
v_mov_b32 v80, v72
v_mov_b32 v81, v73
v_mov_b32 v82, v74
v_mov_b32 v83, v75
v_permlane16_swap_b32 v80, v72
v_permlane16_swap_b32 v81, v73
v_permlane16_swap_b32 v82, v74
v_permlane16_swap_b32 v83, v75
v_add_f32 v72, v72, v80
v_add_f32 v73, v73, v81
v_add_f32 v74, v74, v82
v_add_f32 v75, v75, v83
v_mov_b32 v80, v72
v_mov_b32 v81, v73
v_mov_b32 v82, v74
v_mov_b32 v83, v75
v_permlane32_swap_b32 v80, v72
v_permlane32_swap_b32 v81, v73
v_permlane32_swap_b32 v82, v74
v_permlane32_swap_b32 v83, v75
v_add_f32 v72, v72, v80
v_add_f32 v73, v73, v81
v_add_f32 v74, v74, v82
v_add_f32 v75, v75, v83
ds_write_b128 v133, v[72:75]
s_waitcnt lgkmcnt(0)
L_A_cw:
s_waitcnt vmcnt(0)
s_barrier
s_cmp_eq_u32 s6, 0
s_cbranch_scc1 L_A_nocarry
ds_read_b128 v[76:79], v133
s_waitcnt lgkmcnt(0)
v_pk_mul_f32 v[72:73], v[76:77], v[188:189] op_sel:[0,0] op_sel_hi:[1,0]
v_pk_fma_f32 v[72:73], v[76:77], v[188:189], v[72:73] op_sel:[1,1,0] op_sel_hi:[0,1,1] neg_lo:[0,1,0]
v_pk_mul_f32 v[74:75], v[78:79], v[190:191] op_sel:[0,0] op_sel_hi:[1,0]
v_pk_fma_f32 v[74:75], v[78:79], v[190:191], v[74:75] op_sel:[1,1,0] op_sel_hi:[0,1,1] neg_lo:[0,1,0]
s_branch L_A_fin
L_A_nocarry:
v_mov_b32 v72, 0
v_mov_b32 v73, 0
v_mov_b32 v74, 0
v_mov_b32 v75, 0
L_A_fin:
v_pk_fma_f32 v[96:97], v[196:197], v[72:73], v[96:97] op_sel:[0,0,0] op_sel_hi:[1,0,1]
v_pk_fma_f32 v[98:99], v[198:199], v[74:75], v[98:99] op_sel:[0,0,0] op_sel_hi:[1,0,1]
v_pk_fma_f32 v[96:97], v[196:197], v[72:73], v[96:97] op_sel:[1,1,0] op_sel_hi:[0,1,1] neg_lo:[0,1,0]
v_pk_fma_f32 v[98:99], v[198:199], v[74:75], v[98:99] op_sel:[1,1,0] op_sel_hi:[0,1,1] neg_lo:[0,1,0]
v_pk_fma_f32 v[100:101], v[200:201], v[72:73], v[100:101] op_sel:[0,0,0] op_sel_hi:[1,0,1]
v_pk_fma_f32 v[102:103], v[202:203], v[74:75], v[102:103] op_sel:[0,0,0] op_sel_hi:[1,0,1]
v_pk_fma_f32 v[100:101], v[200:201], v[72:73], v[100:101] op_sel:[1,1,0] op_sel_hi:[0,1,1] neg_lo:[0,1,0]
v_pk_fma_f32 v[102:103], v[202:203], v[74:75], v[102:103] op_sel:[1,1,0] op_sel_hi:[0,1,1] neg_lo:[0,1,0]
v_pk_fma_f32 v[104:105], v[204:205], v[72:73], v[104:105] op_sel:[0,0,0] op_sel_hi:[1,0,1]
v_pk_fma_f32 v[106:107], v[206:207], v[74:75], v[106:107] op_sel:[0,0,0] op_sel_hi:[1,0,1]
v_pk_fma_f32 v[104:105], v[204:205], v[72:73], v[104:105] op_sel:[1,1,0] op_sel_hi:[0,1,1] neg_lo:[0,1,0]
v_pk_fma_f32 v[106:107], v[206:207], v[74:75], v[106:107] op_sel:[1,1,0] op_sel_hi:[0,1,1] neg_lo:[0,1,0]
v_pk_fma_f32 v[108:109], v[208:209], v[72:73], v[108:109] op_sel:[0,0,0] op_sel_hi:[1,0,1]
v_pk_fma_f32 v[110:111], v[210:211], v[74:75], v[110:111] op_sel:[0,0,0] op_sel_hi:[1,0,1]
v_pk_fma_f32 v[108:109], v[208:209], v[72:73], v[108:109] op_sel:[1,1,0] op_sel_hi:[0,1,1] neg_lo:[0,1,0]
v_pk_fma_f32 v[110:111], v[210:211], v[74:75], v[110:111] op_sel:[1,1,0] op_sel_hi:[0,1,1] neg_lo:[0,1,0]
v_cvt_pk_bf16_f32 v144, v96, v98
v_cvt_pk_bf16_f32 v152, -v97, -v99
v_cvt_pk_bf16_f32 v145, v100, v102
v_cvt_pk_bf16_f32 v153, -v101, -v103
v_cvt_pk_bf16_f32 v146, v104, v106
v_cvt_pk_bf16_f32 v154, -v105, -v107
v_cvt_pk_bf16_f32 v147, v108, v110
v_cvt_pk_bf16_f32 v155, -v109, -v111
v_mov_b32 v48, v144
v_mov_b32 v49, v146
v_mov_b32 v50, v152
v_mov_b32 v51, v154
v_mov_b32_dpp v144, v145 row_shr:4 row_mask:0xf bank_mask:0xa
v_mov_b32_dpp v146, v147 row_shr:4 row_mask:0xf bank_mask:0xa
v_mov_b32_dpp v152, v153 row_shr:4 row_mask:0xf bank_mask:0xa
v_mov_b32_dpp v154, v155 row_shr:4 row_mask:0xf bank_mask:0xa
v_mov_b32_dpp v145, v48 row_shl:4 row_mask:0xf bank_mask:0x5
v_mov_b32_dpp v147, v49 row_shl:4 row_mask:0xf bank_mask:0x5
v_mov_b32_dpp v153, v50 row_shl:4 row_mask:0xf bank_mask:0x5
v_mov_b32_dpp v155, v51 row_shl:4 row_mask:0xf bank_mask:0x5
v_mov_b32 v48, v144
v_mov_b32 v49, v145
v_mov_b32 v50, v152
v_mov_b32 v51, v153
v_mov_b32_dpp v144, v146 row_shr:8 row_mask:0xf bank_mask:0xc
v_mov_b32_dpp v145, v147 row_shr:8 row_mask:0xf bank_mask:0xc
v_mov_b32_dpp v152, v154 row_shr:8 row_mask:0xf bank_mask:0xc
v_mov_b32_dpp v153, v155 row_shr:8 row_mask:0xf bank_mask:0xc
v_mov_b32_dpp v146, v48 row_shl:8 row_mask:0xf bank_mask:0x3
v_mov_b32_dpp v147, v49 row_shl:8 row_mask:0xf bank_mask:0x3
v_mov_b32_dpp v154, v50 row_shl:8 row_mask:0xf bank_mask:0x3
v_mov_b32_dpp v155, v51 row_shl:8 row_mask:0xf bank_mask:0x3
buffer_store_dwordx4 v[144:147], v134, s[68:71], s80 offen offset:0 sc1
buffer_store_dwordx4 v[152:155], v134, s[68:71], s81 offen offset:0 sc1
v_pk_fma_f32 v[112:113], v[212:213], v[72:73], v[112:113] op_sel:[0,0,0] op_sel_hi:[1,0,1]
v_pk_fma_f32 v[114:115], v[214:215], v[74:75], v[114:115] op_sel:[0,0,0] op_sel_hi:[1,0,1]
v_pk_fma_f32 v[112:113], v[212:213], v[72:73], v[112:113] op_sel:[1,1,0] op_sel_hi:[0,1,1] neg_lo:[0,1,0]
v_pk_fma_f32 v[114:115], v[214:215], v[74:75], v[114:115] op_sel:[1,1,0] op_sel_hi:[0,1,1] neg_lo:[0,1,0]
v_pk_fma_f32 v[116:117], v[216:217], v[72:73], v[116:117] op_sel:[0,0,0] op_sel_hi:[1,0,1]
v_pk_fma_f32 v[118:119], v[218:219], v[74:75], v[118:119] op_sel:[0,0,0] op_sel_hi:[1,0,1]
v_pk_fma_f32 v[116:117], v[216:217], v[72:73], v[116:117] op_sel:[1,1,0] op_sel_hi:[0,1,1] neg_lo:[0,1,0]
v_pk_fma_f32 v[118:119], v[218:219], v[74:75], v[118:119] op_sel:[1,1,0] op_sel_hi:[0,1,1] neg_lo:[0,1,0]
v_pk_fma_f32 v[120:121], v[220:221], v[72:73], v[120:121] op_sel:[0,0,0] op_sel_hi:[1,0,1]
v_pk_fma_f32 v[122:123], v[222:223], v[74:75], v[122:123] op_sel:[0,0,0] op_sel_hi:[1,0,1]
v_pk_fma_f32 v[120:121], v[220:221], v[72:73], v[120:121] op_sel:[1,1,0] op_sel_hi:[0,1,1] neg_lo:[0,1,0]
v_pk_fma_f32 v[122:123], v[222:223], v[74:75], v[122:123] op_sel:[1,1,0] op_sel_hi:[0,1,1] neg_lo:[0,1,0]
v_pk_fma_f32 v[124:125], v[224:225], v[72:73], v[124:125] op_sel:[0,0,0] op_sel_hi:[1,0,1]
v_pk_fma_f32 v[126:127], v[226:227], v[74:75], v[126:127] op_sel:[0,0,0] op_sel_hi:[1,0,1]
v_pk_fma_f32 v[124:125], v[224:225], v[72:73], v[124:125] op_sel:[1,1,0] op_sel_hi:[0,1,1] neg_lo:[0,1,0]
v_pk_fma_f32 v[126:127], v[226:227], v[74:75], v[126:127] op_sel:[1,1,0] op_sel_hi:[0,1,1] neg_lo:[0,1,0]
v_cvt_pk_bf16_f32 v148, v112, v114
v_cvt_pk_bf16_f32 v156, -v113, -v115
v_cvt_pk_bf16_f32 v149, v116, v118
v_cvt_pk_bf16_f32 v157, -v117, -v119
v_cvt_pk_bf16_f32 v150, v120, v122
v_cvt_pk_bf16_f32 v158, -v121, -v123
v_cvt_pk_bf16_f32 v151, v124, v126
v_cvt_pk_bf16_f32 v159, -v125, -v127
v_mov_b32 v48, v148
v_mov_b32 v49, v150
v_mov_b32 v50, v156
v_mov_b32 v51, v158
v_mov_b32_dpp v148, v149 row_shr:4 row_mask:0xf bank_mask:0xa
v_mov_b32_dpp v150, v151 row_shr:4 row_mask:0xf bank_mask:0xa
v_mov_b32_dpp v156, v157 row_shr:4 row_mask:0xf bank_mask:0xa
v_mov_b32_dpp v158, v159 row_shr:4 row_mask:0xf bank_mask:0xa
v_mov_b32_dpp v149, v48 row_shl:4 row_mask:0xf bank_mask:0x5
v_mov_b32_dpp v151, v49 row_shl:4 row_mask:0xf bank_mask:0x5
v_mov_b32_dpp v157, v50 row_shl:4 row_mask:0xf bank_mask:0x5
v_mov_b32_dpp v159, v51 row_shl:4 row_mask:0xf bank_mask:0x5
v_mov_b32 v48, v148
v_mov_b32 v49, v149
v_mov_b32 v50, v156
v_mov_b32 v51, v157
v_mov_b32_dpp v148, v150 row_shr:8 row_mask:0xf bank_mask:0xc
v_mov_b32_dpp v149, v151 row_shr:8 row_mask:0xf bank_mask:0xc
v_mov_b32_dpp v156, v158 row_shr:8 row_mask:0xf bank_mask:0xc
v_mov_b32_dpp v157, v159 row_shr:8 row_mask:0xf bank_mask:0xc
v_mov_b32_dpp v150, v48 row_shl:8 row_mask:0xf bank_mask:0x3
v_mov_b32_dpp v151, v49 row_shl:8 row_mask:0xf bank_mask:0x3
v_mov_b32_dpp v158, v50 row_shl:8 row_mask:0xf bank_mask:0x3
v_mov_b32_dpp v159, v51 row_shl:8 row_mask:0xf bank_mask:0x3
buffer_store_dwordx4 v[148:151], v134, s[68:71], s80 offen offset:512 sc1
buffer_store_dwordx4 v[156:159], v134, s[68:71], s81 offen offset:512 sc1
v_lshlrev_b32 v16, 16, v240
v_and_b32 v17, 0xffff0000, v240
v_lshlrev_b32 v32, 16, v248
v_and_b32 v33, 0xffff0000, v248
v_mul_f32 v16, v16, v32
v_mul_f32 v17, v17, v33
v_cvt_pk_bf16_f32 v32, v16, v17
v_lshlrev_b32 v16, 16, v32
v_and_b32 v17, 0xffff0000, v32
v_lshlrev_b32 v18, 16, v241
v_and_b32 v19, 0xffff0000, v241
v_lshlrev_b32 v32, 16, v249
v_and_b32 v33, 0xffff0000, v249
v_mul_f32 v18, v18, v32
v_mul_f32 v19, v19, v33
v_cvt_pk_bf16_f32 v32, v18, v19
v_lshlrev_b32 v18, 16, v32
v_and_b32 v19, 0xffff0000, v32
v_lshlrev_b32 v20, 16, v242
v_and_b32 v21, 0xffff0000, v242
v_lshlrev_b32 v32, 16, v250
v_and_b32 v33, 0xffff0000, v250
v_mul_f32 v20, v20, v32
v_mul_f32 v21, v21, v33
v_cvt_pk_bf16_f32 v32, v20, v21
v_lshlrev_b32 v20, 16, v32
v_and_b32 v21, 0xffff0000, v32
v_lshlrev_b32 v22, 16, v243
v_and_b32 v23, 0xffff0000, v243
v_lshlrev_b32 v32, 16, v251
v_and_b32 v33, 0xffff0000, v251
v_mul_f32 v22, v22, v32
v_mul_f32 v23, v23, v33
v_cvt_pk_bf16_f32 v32, v22, v23
v_lshlrev_b32 v22, 16, v32
v_and_b32 v23, 0xffff0000, v32
v_lshlrev_b32 v24, 16, v244
v_and_b32 v25, 0xffff0000, v244
v_lshlrev_b32 v32, 16, v252
v_and_b32 v33, 0xffff0000, v252
v_mul_f32 v24, v24, v32
v_mul_f32 v25, v25, v33
v_cvt_pk_bf16_f32 v32, v24, v25
v_lshlrev_b32 v24, 16, v32
v_and_b32 v25, 0xffff0000, v32
v_lshlrev_b32 v26, 16, v245
v_and_b32 v27, 0xffff0000, v245
v_lshlrev_b32 v32, 16, v253
v_and_b32 v33, 0xffff0000, v253
v_mul_f32 v26, v26, v32
v_mul_f32 v27, v27, v33
v_cvt_pk_bf16_f32 v32, v26, v27
v_lshlrev_b32 v26, 16, v32
v_and_b32 v27, 0xffff0000, v32
v_lshlrev_b32 v28, 16, v246
v_and_b32 v29, 0xffff0000, v246
v_lshlrev_b32 v32, 16, v254
v_and_b32 v33, 0xffff0000, v254
v_mul_f32 v28, v28, v32
v_mul_f32 v29, v29, v33
v_cvt_pk_bf16_f32 v32, v28, v29
v_lshlrev_b32 v28, 16, v32
v_and_b32 v29, 0xffff0000, v32
v_lshlrev_b32 v30, 16, v247
v_and_b32 v31, 0xffff0000, v247
v_lshlrev_b32 v32, 16, v255
v_and_b32 v33, 0xffff0000, v255
v_mul_f32 v30, v30, v32
v_mul_f32 v31, v31, v33
v_cvt_pk_bf16_f32 v32, v30, v31
v_lshlrev_b32 v30, 16, v32
v_and_b32 v31, 0xffff0000, v32
v_bfe_u32 v6, v2, 2, 1
v_lshlrev_b32 v6, 5, v6
v_lshl_add_u32 v6, v3, 3, v6
v_lshrrev_b32 v7, 3, v2
v_lshl_add_u32 v6, v7, 2, v6
v_and_b32 v7, 3, v2
v_add_u32 v6, v6, v7
v_lshlrev_b32 v6, 4, v6
v_lshlrev_b32 v112, 2, v2
v_or_b32 v7, 0, v3
v_xor_b32 v7, v7, v2
v_lshlrev_b32 v7, 4, v7
v_lshl_add_u32 v8, v2, 10, v7
v_add_u32 v12, 0x10000, v8
v_or_b32 v7, 4, v3
v_xor_b32 v7, v7, v2
v_lshlrev_b32 v7, 4, v7
v_lshl_add_u32 v9, v2, 10, v7
v_add_u32 v13, 0x10000, v9
v_or_b32 v7, 8, v3
v_xor_b32 v7, v7, v2
v_lshlrev_b32 v7, 4, v7
v_lshl_add_u32 v10, v2, 10, v7
v_add_u32 v14, 0x10000, v10
v_or_b32 v7, 12, v3
v_xor_b32 v7, v7, v2
v_lshlrev_b32 v7, 4, v7
v_lshl_add_u32 v11, v2, 10, v7
v_add_u32 v15, 0x10000, v11
s_mov_b32 s72, s44
s_and_b32 s73, s45, 0xffff
s_mov_b32 s74, 8388608
s_mov_b32 s75, 0x00020000
s_lshl_b32 s78, s82, 3
s_add_u32 s78, s78, s39
s_lshl_b32 s81, s82, 10
s_lshl_b32 s76, s34, 6
s_add_u32 s81, s81, s76
s_add_u32 s81, s81, 65536
s_lshl_b32 s78, s78, 15
s_add_u32 s78, s78, 1048576
s_lshr_b32 s80, s83, 1
v_and_b32 v228, 7, v1
v_lshlrev_b32 v228, 2, v228
v_mov_b32 v229, 0
s_waitcnt vmcnt(0)
s_barrier
s_cmp_lg_u32 s3, 0
s_cbranch_scc1 L_A_np
s_lshl_b32 s76, s83, 2
s_add_u32 s76, s76, s81
s_waitcnt vmcnt(0)
s_mov_b64 exec, 1
buffer_store_dword v5, v229, s[68:71], s76 offen sc1
s_mov_b64 exec, -1
s_mov_b32 s77, 0x40000
L_fp_11:
buffer_load_dword v7, v228, s[68:71], s81 offen sc1
s_waitcnt vmcnt(0)
v_cmp_eq_u32 vcc, -1, v7
s_cbranch_vccz L_fpd_12
s_sleep 1
s_sub_u32 s77, s77, 1
s_cmp_lg_u32 s77, 0
s_cbranch_scc1 L_fp_11
L_fpd_12:
L_A_np:
s_add_u32 s76, s83, 0
s_and_b32 s76, s76, 7
s_lshl_b32 s76, s76, 11
s_add_u32 s76, s76, s78
s_add_u32 s79, s76, 16384
buffer_load_dwordx4 v[96:99], v6, s[68:71], s76 offen offset:0 sc1
buffer_load_dwordx4 v[100:103], v6, s[68:71], s76 offen offset:1024 sc1
buffer_load_dwordx4 v[104:107], v6, s[68:71], s79 offen offset:0 sc1
buffer_load_dwordx4 v[108:111], v6, s[68:71], s79 offen offset:1024 sc1
ds_read_b128 v[32:35], v8 offset:0
ds_read_b128 v[36:39], v8 offset:16384
ds_read_b128 v[40:43], v8 offset:32768
ds_read_b128 v[44:47], v8 offset:49152
ds_read_b128 v[48:51], v9 offset:0
ds_read_b128 v[52:55], v9 offset:16384
ds_read_b128 v[56:59], v9 offset:32768
ds_read_b128 v[60:63], v9 offset:49152
s_barrier
s_add_u32 s76, s83, 1
s_and_b32 s76, s76, 7
s_lshl_b32 s76, s76, 11
s_add_u32 s76, s76, s78
s_add_u32 s79, s76, 16384
buffer_load_dwordx4 v[112:115], v6, s[68:71], s76 offen offset:0 sc1
buffer_load_dwordx4 v[116:119], v6, s[68:71], s76 offen offset:1024 sc1
buffer_load_dwordx4 v[120:123], v6, s[68:71], s79 offen offset:0 sc1
buffer_load_dwordx4 v[124:127], v6, s[68:71], s79 offen offset:1024 sc1
s_add_u32 s76, s83, 2
s_and_b32 s76, s76, 7
s_lshl_b32 s76, s76, 11
s_add_u32 s76, s76, s78
s_add_u32 s79, s76, 16384
buffer_load_dwordx4 v[128:131], v6, s[68:71], s76 offen offset:0 sc1
buffer_load_dwordx4 v[132:135], v6, s[68:71], s76 offen offset:1024 sc1
s_waitcnt vmcnt(9)
s_waitcnt lgkmcnt(7)
v_mfma_f32_16x16x32_bf16 v[16:19], v[32:35], v[96:99], v[16:19]
ds_read_b128 v[64:67], v12 offset:0
s_waitcnt lgkmcnt(7)
v_mfma_f32_16x16x32_bf16 v[20:23], v[36:39], v[96:99], v[20:23]
ds_read_b128 v[68:71], v12 offset:16384
s_waitcnt lgkmcnt(7)
v_mfma_f32_16x16x32_bf16 v[24:27], v[40:43], v[96:99], v[24:27]
ds_read_b128 v[72:75], v12 offset:32768
s_waitcnt lgkmcnt(7)
v_mfma_f32_16x16x32_bf16 v[28:31], v[44:47], v[96:99], v[28:31]
ds_read_b128 v[76:79], v12 offset:49152
buffer_load_dwordx4 v[136:139], v6, s[68:71], s79 offen offset:0 sc1
s_waitcnt vmcnt(9)
s_waitcnt lgkmcnt(7)
v_mfma_f32_16x16x32_bf16 v[16:19], v[48:51], v[100:103], v[16:19]
ds_read_b128 v[80:83], v13 offset:0
s_waitcnt lgkmcnt(7)
v_mfma_f32_16x16x32_bf16 v[20:23], v[52:55], v[100:103], v[20:23]
ds_read_b128 v[84:87], v13 offset:16384
s_waitcnt lgkmcnt(7)
v_mfma_f32_16x16x32_bf16 v[24:27], v[56:59], v[100:103], v[24:27]
ds_read_b128 v[88:91], v13 offset:32768
s_waitcnt lgkmcnt(7)
v_mfma_f32_16x16x32_bf16 v[28:31], v[60:63], v[100:103], v[28:31]
ds_read_b128 v[92:95], v13 offset:49152
buffer_load_dwordx4 v[140:143], v6, s[68:71], s79 offen offset:1024 sc1
s_waitcnt vmcnt(9)
s_waitcnt lgkmcnt(7)
v_mfma_f32_16x16x32_bf16 v[16:19], v[64:67], v[104:107], v[16:19]
ds_read_b128 v[32:35], v10 offset:0
s_waitcnt lgkmcnt(7)
v_mfma_f32_16x16x32_bf16 v[20:23], v[68:71], v[104:107], v[20:23]
ds_read_b128 v[36:39], v10 offset:16384
s_waitcnt lgkmcnt(7)
v_mfma_f32_16x16x32_bf16 v[24:27], v[72:75], v[104:107], v[24:27]
ds_read_b128 v[40:43], v10 offset:32768
s_waitcnt lgkmcnt(7)
v_mfma_f32_16x16x32_bf16 v[28:31], v[76:79], v[104:107], v[28:31]
ds_read_b128 v[44:47], v10 offset:49152
s_add_u32 s76, s83, 3
s_and_b32 s76, s76, 7
s_lshl_b32 s76, s76, 11
s_add_u32 s76, s76, s78
s_add_u32 s79, s76, 16384
buffer_load_dwordx4 v[144:147], v6, s[68:71], s76 offen offset:0 sc1
s_waitcnt vmcnt(9)
s_waitcnt lgkmcnt(7)
v_mfma_f32_16x16x32_bf16 v[16:19], v[80:83], v[108:111], v[16:19]
ds_read_b128 v[48:51], v11 offset:0
s_waitcnt lgkmcnt(7)
v_mfma_f32_16x16x32_bf16 v[20:23], v[84:87], v[108:111], v[20:23]
ds_read_b128 v[52:55], v11 offset:16384
s_waitcnt lgkmcnt(7)
v_mfma_f32_16x16x32_bf16 v[24:27], v[88:91], v[108:111], v[24:27]
ds_read_b128 v[56:59], v11 offset:32768
s_waitcnt lgkmcnt(7)
v_mfma_f32_16x16x32_bf16 v[28:31], v[92:95], v[108:111], v[28:31]
ds_read_b128 v[60:63], v11 offset:49152
buffer_load_dwordx4 v[148:151], v6, s[68:71], s76 offen offset:1024 sc1
s_waitcnt vmcnt(9)
s_waitcnt lgkmcnt(7)
v_mfma_f32_16x16x32_bf16 v[16:19], v[32:35], v[112:115], v[16:19]
ds_read_b128 v[64:67], v14 offset:0
s_waitcnt lgkmcnt(7)
v_mfma_f32_16x16x32_bf16 v[20:23], v[36:39], v[112:115], v[20:23]
ds_read_b128 v[68:71], v14 offset:16384
s_waitcnt lgkmcnt(7)
v_mfma_f32_16x16x32_bf16 v[24:27], v[40:43], v[112:115], v[24:27]
ds_read_b128 v[72:75], v14 offset:32768
s_waitcnt lgkmcnt(7)
v_mfma_f32_16x16x32_bf16 v[28:31], v[44:47], v[112:115], v[28:31]
ds_read_b128 v[76:79], v14 offset:49152
buffer_load_dwordx4 v[152:155], v6, s[68:71], s79 offen offset:0 sc1
s_waitcnt vmcnt(9)
s_waitcnt lgkmcnt(7)
v_mfma_f32_16x16x32_bf16 v[16:19], v[48:51], v[116:119], v[16:19]
ds_read_b128 v[80:83], v15 offset:0
s_waitcnt lgkmcnt(7)
v_mfma_f32_16x16x32_bf16 v[20:23], v[52:55], v[116:119], v[20:23]
ds_read_b128 v[84:87], v15 offset:16384
s_waitcnt lgkmcnt(7)
v_mfma_f32_16x16x32_bf16 v[24:27], v[56:59], v[116:119], v[24:27]
ds_read_b128 v[88:91], v15 offset:32768
s_waitcnt lgkmcnt(7)
v_mfma_f32_16x16x32_bf16 v[28:31], v[60:63], v[116:119], v[28:31]
ds_read_b128 v[92:95], v15 offset:49152
buffer_load_dwordx4 v[156:159], v6, s[68:71], s79 offen offset:1024 sc1
s_waitcnt vmcnt(9)
s_waitcnt lgkmcnt(7)
v_mfma_f32_16x16x32_bf16 v[16:19], v[64:67], v[120:123], v[16:19]
ds_read_b128 v[32:35], v8 offset:256
s_waitcnt lgkmcnt(7)
v_mfma_f32_16x16x32_bf16 v[20:23], v[68:71], v[120:123], v[20:23]
ds_read_b128 v[36:39], v8 offset:16640
s_waitcnt lgkmcnt(7)
v_mfma_f32_16x16x32_bf16 v[24:27], v[72:75], v[120:123], v[24:27]
ds_read_b128 v[40:43], v8 offset:33024
s_waitcnt lgkmcnt(7)
v_mfma_f32_16x16x32_bf16 v[28:31], v[76:79], v[120:123], v[28:31]
ds_read_b128 v[44:47], v8 offset:49408
s_add_u32 s76, s83, 4
s_and_b32 s76, s76, 7
s_lshl_b32 s76, s76, 11
s_add_u32 s76, s76, s78
s_add_u32 s79, s76, 16384
buffer_load_dwordx4 v[160:163], v6, s[68:71], s76 offen offset:0 sc1
s_waitcnt vmcnt(9)
s_waitcnt lgkmcnt(7)
v_mfma_f32_16x16x32_bf16 v[16:19], v[80:83], v[124:127], v[16:19]
ds_read_b128 v[48:51], v9 offset:256
s_waitcnt lgkmcnt(7)
v_mfma_f32_16x16x32_bf16 v[20:23], v[84:87], v[124:127], v[20:23]
ds_read_b128 v[52:55], v9 offset:16640
s_waitcnt lgkmcnt(7)
v_mfma_f32_16x16x32_bf16 v[24:27], v[88:91], v[124:127], v[24:27]
ds_read_b128 v[56:59], v9 offset:33024
s_waitcnt lgkmcnt(7)
v_mfma_f32_16x16x32_bf16 v[28:31], v[92:95], v[124:127], v[28:31]
ds_read_b128 v[60:63], v9 offset:49408
buffer_load_dwordx4 v[164:167], v6, s[68:71], s76 offen offset:1024 sc1
s_waitcnt vmcnt(9)
s_waitcnt lgkmcnt(7)
v_mfma_f32_16x16x32_bf16 v[16:19], v[32:35], v[128:131], v[16:19]
ds_read_b128 v[64:67], v12 offset:256
s_waitcnt lgkmcnt(7)
v_mfma_f32_16x16x32_bf16 v[20:23], v[36:39], v[128:131], v[20:23]
ds_read_b128 v[68:71], v12 offset:16640
s_waitcnt lgkmcnt(7)
v_mfma_f32_16x16x32_bf16 v[24:27], v[40:43], v[128:131], v[24:27]
ds_read_b128 v[72:75], v12 offset:33024
s_waitcnt lgkmcnt(7)
v_mfma_f32_16x16x32_bf16 v[28:31], v[44:47], v[128:131], v[28:31]
ds_read_b128 v[76:79], v12 offset:49408
buffer_load_dwordx4 v[168:171], v6, s[68:71], s79 offen offset:0 sc1
s_waitcnt vmcnt(9)
s_waitcnt lgkmcnt(7)
v_mfma_f32_16x16x32_bf16 v[16:19], v[48:51], v[132:135], v[16:19]
ds_read_b128 v[80:83], v13 offset:256
s_waitcnt lgkmcnt(7)
v_mfma_f32_16x16x32_bf16 v[20:23], v[52:55], v[132:135], v[20:23]
ds_read_b128 v[84:87], v13 offset:16640
s_waitcnt lgkmcnt(7)
v_mfma_f32_16x16x32_bf16 v[24:27], v[56:59], v[132:135], v[24:27]
ds_read_b128 v[88:91], v13 offset:33024
s_waitcnt lgkmcnt(7)
v_mfma_f32_16x16x32_bf16 v[28:31], v[60:63], v[132:135], v[28:31]
ds_read_b128 v[92:95], v13 offset:49408
buffer_load_dwordx4 v[172:175], v6, s[68:71], s79 offen offset:1024 sc1
s_waitcnt vmcnt(9)
s_waitcnt lgkmcnt(7)
v_mfma_f32_16x16x32_bf16 v[16:19], v[64:67], v[136:139], v[16:19]
ds_read_b128 v[32:35], v10 offset:256
s_waitcnt lgkmcnt(7)
v_mfma_f32_16x16x32_bf16 v[20:23], v[68:71], v[136:139], v[20:23]
ds_read_b128 v[36:39], v10 offset:16640
s_waitcnt lgkmcnt(7)
v_mfma_f32_16x16x32_bf16 v[24:27], v[72:75], v[136:139], v[24:27]
ds_read_b128 v[40:43], v10 offset:33024
s_waitcnt lgkmcnt(7)
v_mfma_f32_16x16x32_bf16 v[28:31], v[76:79], v[136:139], v[28:31]
ds_read_b128 v[44:47], v10 offset:49408
s_add_u32 s76, s83, 5
s_and_b32 s76, s76, 7
s_lshl_b32 s76, s76, 11
s_add_u32 s76, s76, s78
s_add_u32 s79, s76, 16384
buffer_load_dwordx4 v[176:179], v6, s[68:71], s76 offen offset:0 sc1
s_waitcnt vmcnt(9)
s_waitcnt lgkmcnt(7)
v_mfma_f32_16x16x32_bf16 v[16:19], v[80:83], v[140:143], v[16:19]
ds_read_b128 v[48:51], v11 offset:256
s_waitcnt lgkmcnt(7)
v_mfma_f32_16x16x32_bf16 v[20:23], v[84:87], v[140:143], v[20:23]
ds_read_b128 v[52:55], v11 offset:16640
s_waitcnt lgkmcnt(7)
v_mfma_f32_16x16x32_bf16 v[24:27], v[88:91], v[140:143], v[24:27]
ds_read_b128 v[56:59], v11 offset:33024
s_waitcnt lgkmcnt(7)
v_mfma_f32_16x16x32_bf16 v[28:31], v[92:95], v[140:143], v[28:31]
ds_read_b128 v[60:63], v11 offset:49408
buffer_load_dwordx4 v[180:183], v6, s[68:71], s76 offen offset:1024 sc1
s_waitcnt vmcnt(9)
s_waitcnt lgkmcnt(7)
v_mfma_f32_16x16x32_bf16 v[16:19], v[32:35], v[144:147], v[16:19]
ds_read_b128 v[64:67], v14 offset:256
s_waitcnt lgkmcnt(7)
v_mfma_f32_16x16x32_bf16 v[20:23], v[36:39], v[144:147], v[20:23]
ds_read_b128 v[68:71], v14 offset:16640
s_waitcnt lgkmcnt(7)
v_mfma_f32_16x16x32_bf16 v[24:27], v[40:43], v[144:147], v[24:27]
ds_read_b128 v[72:75], v14 offset:33024
s_waitcnt lgkmcnt(7)
v_mfma_f32_16x16x32_bf16 v[28:31], v[44:47], v[144:147], v[28:31]
ds_read_b128 v[76:79], v14 offset:49408
buffer_load_dwordx4 v[184:187], v6, s[68:71], s79 offen offset:0 sc1
s_waitcnt vmcnt(9)
s_waitcnt lgkmcnt(7)
v_mfma_f32_16x16x32_bf16 v[16:19], v[48:51], v[148:151], v[16:19]
ds_read_b128 v[80:83], v15 offset:256
s_waitcnt lgkmcnt(7)
v_mfma_f32_16x16x32_bf16 v[20:23], v[52:55], v[148:151], v[20:23]
ds_read_b128 v[84:87], v15 offset:16640
s_waitcnt lgkmcnt(7)
v_mfma_f32_16x16x32_bf16 v[24:27], v[56:59], v[148:151], v[24:27]
ds_read_b128 v[88:91], v15 offset:33024
s_waitcnt lgkmcnt(7)
v_mfma_f32_16x16x32_bf16 v[28:31], v[60:63], v[148:151], v[28:31]
ds_read_b128 v[92:95], v15 offset:49408
buffer_load_dwordx4 v[188:191], v6, s[68:71], s79 offen offset:1024 sc1
s_waitcnt vmcnt(9)
s_waitcnt lgkmcnt(7)
v_mfma_f32_16x16x32_bf16 v[16:19], v[64:67], v[152:155], v[16:19]
ds_read_b128 v[32:35], v8 offset:512
s_waitcnt lgkmcnt(7)
v_mfma_f32_16x16x32_bf16 v[20:23], v[68:71], v[152:155], v[20:23]
ds_read_b128 v[36:39], v8 offset:16896
s_waitcnt lgkmcnt(7)
v_mfma_f32_16x16x32_bf16 v[24:27], v[72:75], v[152:155], v[24:27]
ds_read_b128 v[40:43], v8 offset:33280
s_waitcnt lgkmcnt(7)
v_mfma_f32_16x16x32_bf16 v[28:31], v[76:79], v[152:155], v[28:31]
ds_read_b128 v[44:47], v8 offset:49664
s_add_u32 s76, s83, 6
s_and_b32 s76, s76, 7
s_lshl_b32 s76, s76, 11
s_add_u32 s76, s76, s78
s_add_u32 s79, s76, 16384
buffer_load_dwordx4 v[192:195], v6, s[68:71], s76 offen offset:0 sc1
s_waitcnt vmcnt(9)
s_waitcnt lgkmcnt(7)
v_mfma_f32_16x16x32_bf16 v[16:19], v[80:83], v[156:159], v[16:19]
ds_read_b128 v[48:51], v9 offset:512
s_waitcnt lgkmcnt(7)
v_mfma_f32_16x16x32_bf16 v[20:23], v[84:87], v[156:159], v[20:23]
ds_read_b128 v[52:55], v9 offset:16896
s_waitcnt lgkmcnt(7)
v_mfma_f32_16x16x32_bf16 v[24:27], v[88:91], v[156:159], v[24:27]
ds_read_b128 v[56:59], v9 offset:33280
s_waitcnt lgkmcnt(7)
v_mfma_f32_16x16x32_bf16 v[28:31], v[92:95], v[156:159], v[28:31]
ds_read_b128 v[60:63], v9 offset:49664
buffer_load_dwordx4 v[196:199], v6, s[68:71], s76 offen offset:1024 sc1
s_waitcnt vmcnt(9)
s_waitcnt lgkmcnt(7)
v_mfma_f32_16x16x32_bf16 v[16:19], v[32:35], v[160:163], v[16:19]
ds_read_b128 v[64:67], v12 offset:512
s_waitcnt lgkmcnt(7)
v_mfma_f32_16x16x32_bf16 v[20:23], v[36:39], v[160:163], v[20:23]
ds_read_b128 v[68:71], v12 offset:16896
s_waitcnt lgkmcnt(7)
v_mfma_f32_16x16x32_bf16 v[24:27], v[40:43], v[160:163], v[24:27]
ds_read_b128 v[72:75], v12 offset:33280
s_waitcnt lgkmcnt(7)
v_mfma_f32_16x16x32_bf16 v[28:31], v[44:47], v[160:163], v[28:31]
ds_read_b128 v[76:79], v12 offset:49664
buffer_load_dwordx4 v[200:203], v6, s[68:71], s79 offen offset:0 sc1
s_waitcnt vmcnt(9)
s_waitcnt lgkmcnt(7)
v_mfma_f32_16x16x32_bf16 v[16:19], v[48:51], v[164:167], v[16:19]
ds_read_b128 v[80:83], v13 offset:512
s_waitcnt lgkmcnt(7)
v_mfma_f32_16x16x32_bf16 v[20:23], v[52:55], v[164:167], v[20:23]
ds_read_b128 v[84:87], v13 offset:16896
s_waitcnt lgkmcnt(7)
v_mfma_f32_16x16x32_bf16 v[24:27], v[56:59], v[164:167], v[24:27]
ds_read_b128 v[88:91], v13 offset:33280
s_waitcnt lgkmcnt(7)
v_mfma_f32_16x16x32_bf16 v[28:31], v[60:63], v[164:167], v[28:31]
ds_read_b128 v[92:95], v13 offset:49664
buffer_load_dwordx4 v[204:207], v6, s[68:71], s79 offen offset:1024 sc1
s_waitcnt vmcnt(9)
s_waitcnt lgkmcnt(7)
v_mfma_f32_16x16x32_bf16 v[16:19], v[64:67], v[168:171], v[16:19]
ds_read_b128 v[32:35], v10 offset:512
s_waitcnt lgkmcnt(7)
v_mfma_f32_16x16x32_bf16 v[20:23], v[68:71], v[168:171], v[20:23]
ds_read_b128 v[36:39], v10 offset:16896
s_waitcnt lgkmcnt(7)
v_mfma_f32_16x16x32_bf16 v[24:27], v[72:75], v[168:171], v[24:27]
ds_read_b128 v[40:43], v10 offset:33280
s_waitcnt lgkmcnt(7)
v_mfma_f32_16x16x32_bf16 v[28:31], v[76:79], v[168:171], v[28:31]
ds_read_b128 v[44:47], v10 offset:49664
s_add_u32 s76, s83, 7
s_and_b32 s76, s76, 7
s_lshl_b32 s76, s76, 11
s_add_u32 s76, s76, s78
s_add_u32 s79, s76, 16384
buffer_load_dwordx4 v[208:211], v6, s[68:71], s76 offen offset:0 sc1
s_waitcnt vmcnt(9)
s_waitcnt lgkmcnt(7)
v_mfma_f32_16x16x32_bf16 v[16:19], v[80:83], v[172:175], v[16:19]
ds_read_b128 v[48:51], v11 offset:512
s_waitcnt lgkmcnt(7)
v_mfma_f32_16x16x32_bf16 v[20:23], v[84:87], v[172:175], v[20:23]
ds_read_b128 v[52:55], v11 offset:16896
s_waitcnt lgkmcnt(7)
v_mfma_f32_16x16x32_bf16 v[24:27], v[88:91], v[172:175], v[24:27]
ds_read_b128 v[56:59], v11 offset:33280
s_waitcnt lgkmcnt(7)
v_mfma_f32_16x16x32_bf16 v[28:31], v[92:95], v[172:175], v[28:31]
ds_read_b128 v[60:63], v11 offset:49664
buffer_load_dwordx4 v[212:215], v6, s[68:71], s76 offen offset:1024 sc1
s_waitcnt vmcnt(9)
s_waitcnt lgkmcnt(7)
v_mfma_f32_16x16x32_bf16 v[16:19], v[32:35], v[176:179], v[16:19]
ds_read_b128 v[64:67], v14 offset:512
s_waitcnt lgkmcnt(7)
v_mfma_f32_16x16x32_bf16 v[20:23], v[36:39], v[176:179], v[20:23]
ds_read_b128 v[68:71], v14 offset:16896
s_waitcnt lgkmcnt(7)
v_mfma_f32_16x16x32_bf16 v[24:27], v[40:43], v[176:179], v[24:27]
ds_read_b128 v[72:75], v14 offset:33280
s_waitcnt lgkmcnt(7)
v_mfma_f32_16x16x32_bf16 v[28:31], v[44:47], v[176:179], v[28:31]
ds_read_b128 v[76:79], v14 offset:49664
buffer_load_dwordx4 v[216:219], v6, s[68:71], s79 offen offset:0 sc1
s_waitcnt vmcnt(9)
s_waitcnt lgkmcnt(7)
v_mfma_f32_16x16x32_bf16 v[16:19], v[48:51], v[180:183], v[16:19]
ds_read_b128 v[80:83], v15 offset:512
s_waitcnt lgkmcnt(7)
v_mfma_f32_16x16x32_bf16 v[20:23], v[52:55], v[180:183], v[20:23]
ds_read_b128 v[84:87], v15 offset:16896
s_waitcnt lgkmcnt(7)
v_mfma_f32_16x16x32_bf16 v[24:27], v[56:59], v[180:183], v[24:27]
ds_read_b128 v[88:91], v15 offset:33280
s_waitcnt lgkmcnt(7)
v_mfma_f32_16x16x32_bf16 v[28:31], v[60:63], v[180:183], v[28:31]
ds_read_b128 v[92:95], v15 offset:49664
buffer_load_dwordx4 v[220:223], v6, s[68:71], s79 offen offset:1024 sc1
s_waitcnt vmcnt(9)
s_waitcnt lgkmcnt(7)
v_mfma_f32_16x16x32_bf16 v[16:19], v[64:67], v[184:187], v[16:19]
ds_read_b128 v[32:35], v8 offset:768
s_waitcnt lgkmcnt(7)
v_mfma_f32_16x16x32_bf16 v[20:23], v[68:71], v[184:187], v[20:23]
ds_read_b128 v[36:39], v8 offset:17152
s_waitcnt lgkmcnt(7)
v_mfma_f32_16x16x32_bf16 v[24:27], v[72:75], v[184:187], v[24:27]
ds_read_b128 v[40:43], v8 offset:33536
s_waitcnt lgkmcnt(7)
v_mfma_f32_16x16x32_bf16 v[28:31], v[76:79], v[184:187], v[28:31]
ds_read_b128 v[44:47], v8 offset:49920
s_waitcnt vmcnt(8)
s_waitcnt lgkmcnt(7)
v_mfma_f32_16x16x32_bf16 v[16:19], v[80:83], v[188:191], v[16:19]
ds_read_b128 v[48:51], v9 offset:768
s_waitcnt lgkmcnt(7)
v_mfma_f32_16x16x32_bf16 v[20:23], v[84:87], v[188:191], v[20:23]
ds_read_b128 v[52:55], v9 offset:17152
s_waitcnt lgkmcnt(7)
v_mfma_f32_16x16x32_bf16 v[24:27], v[88:91], v[188:191], v[24:27]
ds_read_b128 v[56:59], v9 offset:33536
s_waitcnt lgkmcnt(7)
v_mfma_f32_16x16x32_bf16 v[28:31], v[92:95], v[188:191], v[28:31]
ds_read_b128 v[60:63], v9 offset:49920
s_waitcnt vmcnt(7)
s_waitcnt lgkmcnt(7)
v_mfma_f32_16x16x32_bf16 v[16:19], v[32:35], v[192:195], v[16:19]
ds_read_b128 v[64:67], v12 offset:768
s_waitcnt lgkmcnt(7)
v_mfma_f32_16x16x32_bf16 v[20:23], v[36:39], v[192:195], v[20:23]
ds_read_b128 v[68:71], v12 offset:17152
s_waitcnt lgkmcnt(7)
v_mfma_f32_16x16x32_bf16 v[24:27], v[40:43], v[192:195], v[24:27]
ds_read_b128 v[72:75], v12 offset:33536
s_waitcnt lgkmcnt(7)
v_mfma_f32_16x16x32_bf16 v[28:31], v[44:47], v[192:195], v[28:31]
ds_read_b128 v[76:79], v12 offset:49920
s_waitcnt vmcnt(6)
s_waitcnt lgkmcnt(7)
v_mfma_f32_16x16x32_bf16 v[16:19], v[48:51], v[196:199], v[16:19]
ds_read_b128 v[80:83], v13 offset:768
s_waitcnt lgkmcnt(7)
v_mfma_f32_16x16x32_bf16 v[20:23], v[52:55], v[196:199], v[20:23]
ds_read_b128 v[84:87], v13 offset:17152
s_waitcnt lgkmcnt(7)
v_mfma_f32_16x16x32_bf16 v[24:27], v[56:59], v[196:199], v[24:27]
ds_read_b128 v[88:91], v13 offset:33536
s_waitcnt lgkmcnt(7)
v_mfma_f32_16x16x32_bf16 v[28:31], v[60:63], v[196:199], v[28:31]
ds_read_b128 v[92:95], v13 offset:49920
s_waitcnt vmcnt(5)
s_waitcnt lgkmcnt(7)
v_mfma_f32_16x16x32_bf16 v[16:19], v[64:67], v[200:203], v[16:19]
ds_read_b128 v[32:35], v10 offset:768
s_waitcnt lgkmcnt(7)
v_mfma_f32_16x16x32_bf16 v[20:23], v[68:71], v[200:203], v[20:23]
ds_read_b128 v[36:39], v10 offset:17152
s_waitcnt lgkmcnt(7)
v_mfma_f32_16x16x32_bf16 v[24:27], v[72:75], v[200:203], v[24:27]
ds_read_b128 v[40:43], v10 offset:33536
s_waitcnt lgkmcnt(7)
v_mfma_f32_16x16x32_bf16 v[28:31], v[76:79], v[200:203], v[28:31]
ds_read_b128 v[44:47], v10 offset:49920
s_waitcnt vmcnt(4)
s_waitcnt lgkmcnt(7)
v_mfma_f32_16x16x32_bf16 v[16:19], v[80:83], v[204:207], v[16:19]
ds_read_b128 v[48:51], v11 offset:768
s_waitcnt lgkmcnt(7)
v_mfma_f32_16x16x32_bf16 v[20:23], v[84:87], v[204:207], v[20:23]
ds_read_b128 v[52:55], v11 offset:17152
s_waitcnt lgkmcnt(7)
v_mfma_f32_16x16x32_bf16 v[24:27], v[88:91], v[204:207], v[24:27]
ds_read_b128 v[56:59], v11 offset:33536
s_waitcnt lgkmcnt(7)
v_mfma_f32_16x16x32_bf16 v[28:31], v[92:95], v[204:207], v[28:31]
ds_read_b128 v[60:63], v11 offset:49920
s_waitcnt vmcnt(3)
s_waitcnt lgkmcnt(7)
v_mfma_f32_16x16x32_bf16 v[16:19], v[32:35], v[208:211], v[16:19]
ds_read_b128 v[64:67], v14 offset:768
s_waitcnt lgkmcnt(7)
v_mfma_f32_16x16x32_bf16 v[20:23], v[36:39], v[208:211], v[20:23]
ds_read_b128 v[68:71], v14 offset:17152
s_waitcnt lgkmcnt(7)
v_mfma_f32_16x16x32_bf16 v[24:27], v[40:43], v[208:211], v[24:27]
ds_read_b128 v[72:75], v14 offset:33536
s_waitcnt lgkmcnt(7)
v_mfma_f32_16x16x32_bf16 v[28:31], v[44:47], v[208:211], v[28:31]
ds_read_b128 v[76:79], v14 offset:49920
s_waitcnt vmcnt(2)
s_waitcnt lgkmcnt(7)
v_mfma_f32_16x16x32_bf16 v[16:19], v[48:51], v[212:215], v[16:19]
ds_read_b128 v[80:83], v15 offset:768
s_waitcnt lgkmcnt(7)
v_mfma_f32_16x16x32_bf16 v[20:23], v[52:55], v[212:215], v[20:23]
ds_read_b128 v[84:87], v15 offset:17152
s_waitcnt lgkmcnt(7)
v_mfma_f32_16x16x32_bf16 v[24:27], v[56:59], v[212:215], v[24:27]
ds_read_b128 v[88:91], v15 offset:33536
s_waitcnt lgkmcnt(7)
v_mfma_f32_16x16x32_bf16 v[28:31], v[60:63], v[212:215], v[28:31]
ds_read_b128 v[92:95], v15 offset:49920
s_waitcnt vmcnt(1)
s_waitcnt lgkmcnt(7)
v_mfma_f32_16x16x32_bf16 v[16:19], v[64:67], v[216:219], v[16:19]
s_waitcnt lgkmcnt(6)
v_mfma_f32_16x16x32_bf16 v[20:23], v[68:71], v[216:219], v[20:23]
s_waitcnt lgkmcnt(5)
v_mfma_f32_16x16x32_bf16 v[24:27], v[72:75], v[216:219], v[24:27]
s_waitcnt lgkmcnt(4)
v_mfma_f32_16x16x32_bf16 v[28:31], v[76:79], v[216:219], v[28:31]
s_waitcnt vmcnt(0)
s_waitcnt lgkmcnt(3)
v_mfma_f32_16x16x32_bf16 v[16:19], v[80:83], v[220:223], v[16:19]
s_waitcnt lgkmcnt(2)
v_mfma_f32_16x16x32_bf16 v[20:23], v[84:87], v[220:223], v[20:23]
s_waitcnt lgkmcnt(1)
v_mfma_f32_16x16x32_bf16 v[24:27], v[88:91], v[220:223], v[24:27]
s_waitcnt lgkmcnt(0)
v_mfma_f32_16x16x32_bf16 v[28:31], v[92:95], v[220:223], v[28:31]
s_lshl_b32 s78, s82, 19
s_lshl_b32 s76, s39, 16
s_add_u32 s78, s78, s76
s_lshl_b32 s76, s83, 8
s_add_u32 s78, s78, s76
v_lshlrev_b32 v6, 4, v3
v_lshl_add_u32 v6, v2, 12, v6
buffer_store_dwordx4 v[16:19], v6, s[72:75], s78 offen offset:0
buffer_store_dwordx4 v[20:23], v6, s[72:75], s78 offen offset:64
buffer_store_dwordx4 v[24:27], v6, s[72:75], s78 offen offset:128
buffer_store_dwordx4 v[28:31], v6, s[72:75], s78 offen offset:192
s_endpgm
L_roleB:
s_lshr_b32 s6, s3, 1
s_and_b32 s7, s3, 1
s_lshl_b32 s51, s4, 6
s_lshl_b32 s76, s5, 2
s_add_u32 s51, s51, s76
s_add_u32 s50, s51, s6
v_lshlrev_b32 v6, 4, v1
v_mov_b32 v16, 0
s_lshl_b32 s76, s50, 8
s_lshl_b32 s77, s7, 7
s_add_u32 s76, s76, s77
v_lshl_add_u32 v8, v1, 1, s76
s_lshl_b32 s76, s50, 1
v_mov_b32 v9, s76
s_lshl_b32 s76, s5, 5
v_add_u32 v7, s76, v0
v_and_b32 v7, 0x1ff, v7
v_lshlrev_b32 v10, 12, v7
s_lshl_b32 s78, s51, 1
s_waitcnt lgkmcnt(0)
s_mov_b32 s52, s26
s_and_b32 s53, s27, 0xffff
s_mov_b32 s54, 2097152
s_mov_b32 s55, 0x00020000
global_load_ushort v20, v8, s[28:29]
global_load_ushort v21, v8, s[30:31]
global_load_ushort v22, v8, s[32:33]
global_load_ushort v23, v8, s[34:35]
global_load_ushort v24, v8, s[36:37]
global_load_ushort v25, v8, s[38:39]
global_load_ushort v26, v9, s[40:41]
global_load_ushort v27, v9, s[42:43]
s_mov_b32 s68, s48
s_and_b32 s69, s49, 0xffff
s_mov_b32 s70, 16777216
s_mov_b32 s71, 0x00020000
s_mov_b32 s72, s44
s_and_b32 s73, s45, 0xffff
s_mov_b32 s74, 8388608
s_mov_b32 s75, 0x00020000
s_cmp_lg_u32 s3, 7
s_cbranch_scc1 L_B_noclean
s_cmp_ge_u32 s2, 144
s_cbranch_scc1 L_B_noclean
v_mov_b32 v12, -1
v_mov_b32 v13, -1
v_mov_b32 v14, -1
v_mov_b32 v15, -1
s_sub_u32 s77, s2, 128
s_mul_i32 s76, s77, 5120
buffer_store_dwordx4 v[12:15], v6, s[68:71], s76 offen sc1
s_add_u32 s76, s76, 1024
buffer_store_dwordx4 v[12:15], v6, s[68:71], s76 offen sc1
s_add_u32 s76, s76, 1024
buffer_store_dwordx4 v[12:15], v6, s[68:71], s76 offen sc1
s_add_u32 s76, s76, 1024
buffer_store_dwordx4 v[12:15], v6, s[68:71], s76 offen sc1
s_add_u32 s76, s76, 1024
buffer_store_dwordx4 v[12:15], v6, s[68:71], s76 offen sc1
s_add_u32 s76, s76, 1024
s_lshl_b32 s76, s77, 2
v_mov_b32 v11, s76
s_waitcnt vmcnt(0)
s_mov_b64 exec, 1
global_store_dword v11, v5, s[46:47] offset:64 sc1
s_mov_b64 exec, -1
L_B_noclean:
s_cmp_lg_u32 s3, 6
s_cbranch_scc1 L_B_nopf
s_getpc_b64 s[76:77]
L_B_pc:
s_sub_u32 s76, s76, L_B_pc-concat_heads__ssm_conv_s5__ssm_conv_s4__prompt_kernel
s_subb_u32 s77, s77, 0
s_and_b32 s79, s5, 7
s_lshl_b32 s79, s79, 12
v_lshl_add_u32 v11, v1, 6, s79
global_load_dword v12, v11, s[76:77]
L_B_nopf:
s_barrier
v_mov_b32 v214, v10
s_mov_b32 s83, s78
s_lshr_b32 s76, s4, 1
s_lshl_b32 s76, s76, 19
s_lshl_b32 s77, s5, 15
s_add_u32 s76, s76, s77
s_lshl_b32 s77, s3, 13
s_add_u32 s76, s76, s77
s_and_b32 s77, s4, 1
s_lshl_b32 s77, s77, 18
s_lshl_b32 s79, s5, 14
s_add_u32 s77, s77, s79
s_and_b32 s79, s3, 1
s_lshl_b32 s79, s79, 13
s_add_u32 s77, s77, s79
s_cmp_ge_u32 s3, 4
s_cselect_b32 s76, s77, s76
s_cselect_b32 s80, s14, s8
s_cselect_b32 s81, s15, s9
s_cmp_ge_u32 s3, 6
s_cselect_b32 s80, s16, s80
s_cselect_b32 s81, s17, s81
v_lshl_add_u32 v210, v1, 7, s76
global_load_dword v211, v210, s[80:81]
s_waitcnt vmcnt(1)
v_lshlrev_b32 v20, 16, v20
v_lshlrev_b32 v21, 16, v21
v_lshlrev_b32 v22, 16, v22
v_lshlrev_b32 v23, 16, v23
v_lshlrev_b32 v24, 16, v24
v_lshlrev_b32 v25, 16, v25
v_lshlrev_b32 v26, 16, v26
v_lshlrev_b32 v27, 16, v27
v_mul_f32 v31, 0x3fb8aa3b, v26
s_mov_b32 s33, 0x3fb8aa3b
v_fma_f32 v32, v26, s33, -v31
v_fmac_f32 v32, 0x32a57060, v26
v_exp_f32 v31, v31
v_mul_f32 v32, 0x3f317218, v32
v_fma_f32 v31, v31, v32, v31
v_cvt_pk_bf16_f32 v30, v31, v31
v_lshlrev_b32 v30, 16, v30
v_mul_f32 v28, v30, v20
v_mul_f32 v29, v30, v21
v_mul_f32 v28, 0x3fb8aa3b, v28
v_mul_f32 v29, 0x3e22f983, v29
v_mul_f32 v22, v30, v22
v_mul_f32 v23, v30, v23
v_pk_mul_f32 v[54:55], v[24:25], v[22:23] op_sel:[0,0] op_sel_hi:[1,0]
v_pk_fma_f32 v[54:55], v[24:25], v[22:23], v[54:55] op_sel:[1,1,0] op_sel_hi:[0,1,1] neg_lo:[0,1,0]
v_mul_f32 v31, 1.0, v28
v_mul_f32 v32, 1.0, v29
v_exp_f32 v31, v31
v_fract_f32 v32, v32
v_cos_f32 v36, v32
v_sin_f32 v37, v32
v_mul_f32 v36, v31, v36
v_mul_f32 v37, v31, v37
v_mul_f32 v31, 0x41000000, v28
v_mul_f32 v32, 0x41000000, v29
v_exp_f32 v31, v31
v_fract_f32 v32, v32
v_cos_f32 v50, v32
v_sin_f32 v51, v32
v_mul_f32 v50, v31, v50
v_mul_f32 v51, v31, v51
v_mul_f32 v31, 0x43000000, v28
v_mul_f32 v32, 0x43000000, v29
v_exp_f32 v31, v31
v_fract_f32 v32, v32
v_cos_f32 v52, v32
v_sin_f32 v53, v32
v_mul_f32 v52, v31, v52
v_mul_f32 v53, v31, v53
s_mul_i32 s76, s3, 4608
s_add_u32 s76, s76, 51840
v_lshl_add_u32 v8, v1, 2, s76
v_mul_u32_u24 v9, 288, v2
v_lshl_add_u32 v9, v3, 4, v9
v_add_u32 v9, s76, v9
s_lshl_b32 s76, s5, 14
s_and_b32 s77, s3, 3
s_lshl_b32 s77, s77, 12
s_add_u32 s76, s76, s77
s_and_b32 s77, s4, 1
s_lshl_b32 s77, s77, 18
s_add_u32 s76, s76, s77
s_cmp_ge_u32 s3, 4
s_cselect_b32 s80, s20, s18
s_cselect_b32 s81, s21, s19
v_and_b32 v212, 31, v1
v_lshl_add_u32 v212, v212, 7, s76
global_load_dword v213, v212, s[80:81]
v_mov_b32 v95, 0x3f80
ds_write_b32 v8, v95
v_cvt_pk_bf16_f32 v92, v50, v51
ds_write_b32 v8, v92 offset:288
v_pk_mul_f32 v[88:89], v[50:51], v[50:51] op_sel:[0,0] op_sel_hi:[1,0]
v_pk_fma_f32 v[88:89], v[50:51], v[50:51], v[88:89] op_sel:[1,1,0] op_sel_hi:[0,1,1] neg_lo:[0,1,0]
v_pk_mul_f32 v[38:39], v[36:37], v[36:37] op_sel:[0,0] op_sel_hi:[1,0]
v_pk_fma_f32 v[38:39], v[36:37], v[36:37], v[38:39] op_sel:[1,1,0] op_sel_hi:[0,1,1] neg_lo:[0,1,0]
v_pk_mul_f32 v[56:57], v[54:55], v[52:53] op_sel:[0,0] op_sel_hi:[1,0]
v_pk_fma_f32 v[56:57], v[54:55], v[52:53], v[56:57] op_sel:[1,1,0] op_sel_hi:[0,1,1] neg_lo:[0,1,0]
v_cvt_pk_bf16_f32 v93, v88, v89
ds_write_b32 v8, v93 offset:576
v_pk_mul_f32 v[90:91], v[88:89], v[50:51] op_sel:[0,0] op_sel_hi:[1,0]
v_pk_fma_f32 v[90:91], v[88:89], v[50:51], v[90:91] op_sel:[1,1,0] op_sel_hi:[0,1,1] neg_lo:[0,1,0]
v_pk_mul_f32 v[40:41], v[38:39], v[36:37] op_sel:[0,0] op_sel_hi:[1,0]
v_pk_fma_f32 v[40:41], v[38:39], v[36:37], v[40:41] op_sel:[1,1,0] op_sel_hi:[0,1,1] neg_lo:[0,1,0]
v_pk_mul_f32 v[58:59], v[56:57], v[52:53] op_sel:[0,0] op_sel_hi:[1,0]
v_pk_fma_f32 v[58:59], v[56:57], v[52:53], v[58:59] op_sel:[1,1,0] op_sel_hi:[0,1,1] neg_lo:[0,1,0]
v_cvt_pk_bf16_f32 v94, v90, v91
ds_write_b32 v8, v94 offset:864
v_pk_mul_f32 v[88:89], v[90:91], v[50:51] op_sel:[0,0] op_sel_hi:[1,0]
v_pk_fma_f32 v[88:89], v[90:91], v[50:51], v[88:89] op_sel:[1,1,0] op_sel_hi:[0,1,1] neg_lo:[0,1,0]
v_pk_mul_f32 v[42:43], v[40:41], v[36:37] op_sel:[0,0] op_sel_hi:[1,0]
v_pk_fma_f32 v[42:43], v[40:41], v[36:37], v[42:43] op_sel:[1,1,0] op_sel_hi:[0,1,1] neg_lo:[0,1,0]
v_pk_mul_f32 v[60:61], v[58:59], v[52:53] op_sel:[0,0] op_sel_hi:[1,0]
v_pk_fma_f32 v[60:61], v[58:59], v[52:53], v[60:61] op_sel:[1,1,0] op_sel_hi:[0,1,1] neg_lo:[0,1,0]
v_cvt_pk_bf16_f32 v95, v88, v89
ds_write_b32 v8, v95 offset:1152
v_pk_mul_f32 v[90:91], v[88:89], v[50:51] op_sel:[0,0] op_sel_hi:[1,0]
v_pk_fma_f32 v[90:91], v[88:89], v[50:51], v[90:91] op_sel:[1,1,0] op_sel_hi:[0,1,1] neg_lo:[0,1,0]
v_pk_mul_f32 v[44:45], v[42:43], v[36:37] op_sel:[0,0] op_sel_hi:[1,0]
v_pk_fma_f32 v[44:45], v[42:43], v[36:37], v[44:45] op_sel:[1,1,0] op_sel_hi:[0,1,1] neg_lo:[0,1,0]
v_pk_mul_f32 v[62:63], v[60:61], v[52:53] op_sel:[0,0] op_sel_hi:[1,0]
v_pk_fma_f32 v[62:63], v[60:61], v[52:53], v[62:63] op_sel:[1,1,0] op_sel_hi:[0,1,1] neg_lo:[0,1,0]
v_cvt_pk_bf16_f32 v92, v90, v91
ds_write_b32 v8, v92 offset:1440
v_pk_mul_f32 v[88:89], v[90:91], v[50:51] op_sel:[0,0] op_sel_hi:[1,0]
v_pk_fma_f32 v[88:89], v[90:91], v[50:51], v[88:89] op_sel:[1,1,0] op_sel_hi:[0,1,1] neg_lo:[0,1,0]
v_pk_mul_f32 v[46:47], v[44:45], v[36:37] op_sel:[0,0] op_sel_hi:[1,0]
v_pk_fma_f32 v[46:47], v[44:45], v[36:37], v[46:47] op_sel:[1,1,0] op_sel_hi:[0,1,1] neg_lo:[0,1,0]
v_pk_mul_f32 v[64:65], v[62:63], v[52:53] op_sel:[0,0] op_sel_hi:[1,0]
v_pk_fma_f32 v[64:65], v[62:63], v[52:53], v[64:65] op_sel:[1,1,0] op_sel_hi:[0,1,1] neg_lo:[0,1,0]
v_cvt_pk_bf16_f32 v93, v88, v89
ds_write_b32 v8, v93 offset:1728
v_pk_mul_f32 v[90:91], v[88:89], v[50:51] op_sel:[0,0] op_sel_hi:[1,0]
v_pk_fma_f32 v[90:91], v[88:89], v[50:51], v[90:91] op_sel:[1,1,0] op_sel_hi:[0,1,1] neg_lo:[0,1,0]
v_pk_mul_f32 v[48:49], v[46:47], v[36:37] op_sel:[0,0] op_sel_hi:[1,0]
v_pk_fma_f32 v[48:49], v[46:47], v[36:37], v[48:49] op_sel:[1,1,0] op_sel_hi:[0,1,1] neg_lo:[0,1,0]
v_pk_mul_f32 v[66:67], v[64:65], v[52:53] op_sel:[0,0] op_sel_hi:[1,0]
v_pk_fma_f32 v[66:67], v[64:65], v[52:53], v[66:67] op_sel:[1,1,0] op_sel_hi:[0,1,1] neg_lo:[0,1,0]
v_cvt_pk_bf16_f32 v94, v90, v91
ds_write_b32 v8, v94 offset:2016
v_pk_mul_f32 v[88:89], v[90:91], v[50:51] op_sel:[0,0] op_sel_hi:[1,0]
v_pk_fma_f32 v[88:89], v[90:91], v[50:51], v[88:89] op_sel:[1,1,0] op_sel_hi:[0,1,1] neg_lo:[0,1,0]
v_pk_mul_f32 v[68:69], v[66:67], v[52:53] op_sel:[0,0] op_sel_hi:[1,0]
v_pk_fma_f32 v[68:69], v[66:67], v[52:53], v[68:69] op_sel:[1,1,0] op_sel_hi:[0,1,1] neg_lo:[0,1,0]
v_cvt_pk_bf16_f32 v95, v88, v89
ds_write_b32 v8, v95 offset:2304
v_pk_mul_f32 v[90:91], v[88:89], v[50:51] op_sel:[0,0] op_sel_hi:[1,0]
v_pk_fma_f32 v[90:91], v[88:89], v[50:51], v[90:91] op_sel:[1,1,0] op_sel_hi:[0,1,1] neg_lo:[0,1,0]
v_pk_mul_f32 v[70:71], v[68:69], v[52:53] op_sel:[0,0] op_sel_hi:[1,0]
v_pk_fma_f32 v[70:71], v[68:69], v[52:53], v[70:71] op_sel:[1,1,0] op_sel_hi:[0,1,1] neg_lo:[0,1,0]
v_cvt_pk_bf16_f32 v92, v90, v91
ds_write_b32 v8, v92 offset:2592
buffer_load_dwordx2 v[200:201], v214, s[52:55], s83 offen offset:0
v_pk_mul_f32 v[88:89], v[90:91], v[50:51] op_sel:[0,0] op_sel_hi:[1,0]
v_pk_fma_f32 v[88:89], v[90:91], v[50:51], v[88:89] op_sel:[1,1,0] op_sel_hi:[0,1,1] neg_lo:[0,1,0]
v_pk_mul_f32 v[72:73], v[70:71], v[52:53] op_sel:[0,0] op_sel_hi:[1,0]
v_pk_fma_f32 v[72:73], v[70:71], v[52:53], v[72:73] op_sel:[1,1,0] op_sel_hi:[0,1,1] neg_lo:[0,1,0]
v_cvt_pk_bf16_f32 v93, v88, v89
ds_write_b32 v8, v93 offset:2880
v_pk_mul_f32 v[90:91], v[88:89], v[50:51] op_sel:[0,0] op_sel_hi:[1,0]
v_pk_fma_f32 v[90:91], v[88:89], v[50:51], v[90:91] op_sel:[1,1,0] op_sel_hi:[0,1,1] neg_lo:[0,1,0]
v_pk_mul_f32 v[74:75], v[72:73], v[52:53] op_sel:[0,0] op_sel_hi:[1,0]
v_pk_fma_f32 v[74:75], v[72:73], v[52:53], v[74:75] op_sel:[1,1,0] op_sel_hi:[0,1,1] neg_lo:[0,1,0]
v_cvt_pk_bf16_f32 v94, v90, v91
ds_write_b32 v8, v94 offset:3168
v_pk_mul_f32 v[88:89], v[90:91], v[50:51] op_sel:[0,0] op_sel_hi:[1,0]
v_pk_fma_f32 v[88:89], v[90:91], v[50:51], v[88:89] op_sel:[1,1,0] op_sel_hi:[0,1,1] neg_lo:[0,1,0]
v_pk_mul_f32 v[76:77], v[74:75], v[52:53] op_sel:[0,0] op_sel_hi:[1,0]
v_pk_fma_f32 v[76:77], v[74:75], v[52:53], v[76:77] op_sel:[1,1,0] op_sel_hi:[0,1,1] neg_lo:[0,1,0]
v_cvt_pk_bf16_f32 v95, v88, v89
ds_write_b32 v8, v95 offset:3456
v_pk_mul_f32 v[90:91], v[88:89], v[50:51] op_sel:[0,0] op_sel_hi:[1,0]
v_pk_fma_f32 v[90:91], v[88:89], v[50:51], v[90:91] op_sel:[1,1,0] op_sel_hi:[0,1,1] neg_lo:[0,1,0]
v_pk_mul_f32 v[78:79], v[76:77], v[52:53] op_sel:[0,0] op_sel_hi:[1,0]
v_pk_fma_f32 v[78:79], v[76:77], v[52:53], v[78:79] op_sel:[1,1,0] op_sel_hi:[0,1,1] neg_lo:[0,1,0]
v_cvt_pk_bf16_f32 v92, v90, v91
ds_write_b32 v8, v92 offset:3744
v_pk_mul_f32 v[88:89], v[90:91], v[50:51] op_sel:[0,0] op_sel_hi:[1,0]
v_pk_fma_f32 v[88:89], v[90:91], v[50:51], v[88:89] op_sel:[1,1,0] op_sel_hi:[0,1,1] neg_lo:[0,1,0]
v_pk_mul_f32 v[80:81], v[78:79], v[52:53] op_sel:[0,0] op_sel_hi:[1,0]
v_pk_fma_f32 v[80:81], v[78:79], v[52:53], v[80:81] op_sel:[1,1,0] op_sel_hi:[0,1,1] neg_lo:[0,1,0]
v_cvt_pk_bf16_f32 v93, v88, v89
ds_write_b32 v8, v93 offset:4032
v_pk_mul_f32 v[90:91], v[88:89], v[50:51] op_sel:[0,0] op_sel_hi:[1,0]
v_pk_fma_f32 v[90:91], v[88:89], v[50:51], v[90:91] op_sel:[1,1,0] op_sel_hi:[0,1,1] neg_lo:[0,1,0]
v_pk_mul_f32 v[82:83], v[80:81], v[52:53] op_sel:[0,0] op_sel_hi:[1,0]
v_pk_fma_f32 v[82:83], v[80:81], v[52:53], v[82:83] op_sel:[1,1,0] op_sel_hi:[0,1,1] neg_lo:[0,1,0]
v_cvt_pk_bf16_f32 v94, v90, v91
ds_write_b32 v8, v94 offset:4320
ds_read_b128 v[96:99], v9 offset:0
ds_read_b128 v[100:103], v9 offset:64
ds_read_b128 v[104:107], v9 offset:128
ds_read_b128 v[108:111], v9 offset:192
v_pk_mul_f32 v[84:85], v[82:83], v[52:53] op_sel:[0,0] op_sel_hi:[1,0]
v_pk_fma_f32 v[84:85], v[82:83], v[52:53], v[84:85] op_sel:[1,1,0] op_sel_hi:[0,1,1] neg_lo:[0,1,0]
v_pk_mul_f32 v[86:87], v[84:85], v[52:53] op_sel:[0,0] op_sel_hi:[1,0]
v_pk_fma_f32 v[86:87], v[84:85], v[52:53], v[86:87] op_sel:[1,1,0] op_sel_hi:[0,1,1] neg_lo:[0,1,0]
buffer_load_dwordx2 v[202:203], v214, s[52:55], s83 offen offset:1024
v_cvt_pk_bf16_f32 v95, v54, -v55
ds_write_b32 v8, v95 offset:0
v_pk_mul_f32 v[88:89], v[54:55], v[36:37] op_sel:[0,0] op_sel_hi:[1,0]
v_pk_fma_f32 v[88:89], v[54:55], v[36:37], v[88:89] op_sel:[1,1,0] op_sel_hi:[0,1,1] neg_lo:[0,1,0]
v_cvt_pk_bf16_f32 v92, v88, -v89
ds_write_b32 v8, v92 offset:288
v_pk_mul_f32 v[90:91], v[54:55], v[38:39] op_sel:[0,0] op_sel_hi:[1,0]
v_pk_fma_f32 v[90:91], v[54:55], v[38:39], v[90:91] op_sel:[1,1,0] op_sel_hi:[0,1,1] neg_lo:[0,1,0]
v_cvt_pk_bf16_f32 v93, v90, -v91
ds_write_b32 v8, v93 offset:576
v_pk_mul_f32 v[88:89], v[54:55], v[40:41] op_sel:[0,0] op_sel_hi:[1,0]
v_pk_fma_f32 v[88:89], v[54:55], v[40:41], v[88:89] op_sel:[1,1,0] op_sel_hi:[0,1,1] neg_lo:[0,1,0]
v_cvt_pk_bf16_f32 v94, v88, -v89
ds_write_b32 v8, v94 offset:864
v_pk_mul_f32 v[90:91], v[54:55], v[42:43] op_sel:[0,0] op_sel_hi:[1,0]
v_pk_fma_f32 v[90:91], v[54:55], v[42:43], v[90:91] op_sel:[1,1,0] op_sel_hi:[0,1,1] neg_lo:[0,1,0]
v_cvt_pk_bf16_f32 v95, v90, -v91
ds_write_b32 v8, v95 offset:1152
v_pk_mul_f32 v[88:89], v[54:55], v[44:45] op_sel:[0,0] op_sel_hi:[1,0]
v_pk_fma_f32 v[88:89], v[54:55], v[44:45], v[88:89] op_sel:[1,1,0] op_sel_hi:[0,1,1] neg_lo:[0,1,0]
v_cvt_pk_bf16_f32 v92, v88, -v89
ds_write_b32 v8, v92 offset:1440
v_pk_mul_f32 v[90:91], v[54:55], v[46:47] op_sel:[0,0] op_sel_hi:[1,0]
v_pk_fma_f32 v[90:91], v[54:55], v[46:47], v[90:91] op_sel:[1,1,0] op_sel_hi:[0,1,1] neg_lo:[0,1,0]
v_cvt_pk_bf16_f32 v93, v90, -v91
ds_write_b32 v8, v93 offset:1728
v_pk_mul_f32 v[88:89], v[54:55], v[48:49] op_sel:[0,0] op_sel_hi:[1,0]
v_pk_fma_f32 v[88:89], v[54:55], v[48:49], v[88:89] op_sel:[1,1,0] op_sel_hi:[0,1,1] neg_lo:[0,1,0]
v_cvt_pk_bf16_f32 v94, v88, -v89
ds_write_b32 v8, v94 offset:2016
v_cvt_pk_bf16_f32 v95, v56, -v57
ds_write_b32 v8, v95 offset:2304
v_pk_mul_f32 v[90:91], v[56:57], v[36:37] op_sel:[0,0] op_sel_hi:[1,0]
v_pk_fma_f32 v[90:91], v[56:57], v[36:37], v[90:91] op_sel:[1,1,0] op_sel_hi:[0,1,1] neg_lo:[0,1,0]
v_cvt_pk_bf16_f32 v92, v90, -v91
ds_write_b32 v8, v92 offset:2592
v_pk_mul_f32 v[88:89], v[56:57], v[38:39] op_sel:[0,0] op_sel_hi:[1,0]
v_pk_fma_f32 v[88:89], v[56:57], v[38:39], v[88:89] op_sel:[1,1,0] op_sel_hi:[0,1,1] neg_lo:[0,1,0]
v_cvt_pk_bf16_f32 v93, v88, -v89
ds_write_b32 v8, v93 offset:2880
v_pk_mul_f32 v[90:91], v[56:57], v[40:41] op_sel:[0,0] op_sel_hi:[1,0]
v_pk_fma_f32 v[90:91], v[56:57], v[40:41], v[90:91] op_sel:[1,1,0] op_sel_hi:[0,1,1] neg_lo:[0,1,0]
v_cvt_pk_bf16_f32 v94, v90, -v91
ds_write_b32 v8, v94 offset:3168
v_pk_mul_f32 v[88:89], v[56:57], v[42:43] op_sel:[0,0] op_sel_hi:[1,0]
v_pk_fma_f32 v[88:89], v[56:57], v[42:43], v[88:89] op_sel:[1,1,0] op_sel_hi:[0,1,1] neg_lo:[0,1,0]
v_cvt_pk_bf16_f32 v95, v88, -v89
ds_write_b32 v8, v95 offset:3456
v_pk_mul_f32 v[90:91], v[56:57], v[44:45] op_sel:[0,0] op_sel_hi:[1,0]
v_pk_fma_f32 v[90:91], v[56:57], v[44:45], v[90:91] op_sel:[1,1,0] op_sel_hi:[0,1,1] neg_lo:[0,1,0]
v_cvt_pk_bf16_f32 v92, v90, -v91
ds_write_b32 v8, v92 offset:3744
v_pk_mul_f32 v[88:89], v[56:57], v[46:47] op_sel:[0,0] op_sel_hi:[1,0]
v_pk_fma_f32 v[88:89], v[56:57], v[46:47], v[88:89] op_sel:[1,1,0] op_sel_hi:[0,1,1] neg_lo:[0,1,0]
v_cvt_pk_bf16_f32 v93, v88, -v89
ds_write_b32 v8, v93 offset:4032
v_pk_mul_f32 v[90:91], v[56:57], v[48:49] op_sel:[0,0] op_sel_hi:[1,0]
v_pk_fma_f32 v[90:91], v[56:57], v[48:49], v[90:91] op_sel:[1,1,0] op_sel_hi:[0,1,1] neg_lo:[0,1,0]
v_cvt_pk_bf16_f32 v94, v90, -v91
ds_write_b32 v8, v94 offset:4320
ds_read_b128 v[112:115], v9 offset:0
ds_read_b128 v[116:119], v9 offset:64
ds_read_b128 v[120:123], v9 offset:128
ds_read_b128 v[124:127], v9 offset:192
buffer_load_dwordx2 v[204:205], v214, s[52:55], s83 offen offset:2048
v_cvt_pk_bf16_f32 v95, v58, -v59
ds_write_b32 v8, v95 offset:0
v_pk_mul_f32 v[88:89], v[58:59], v[38:39] op_sel:[0,0] op_sel_hi:[1,0]
v_pk_fma_f32 v[88:89], v[58:59], v[38:39], v[88:89] op_sel:[1,1,0] op_sel_hi:[0,1,1] neg_lo:[0,1,0]
v_cvt_pk_bf16_f32 v92, v88, -v89
ds_write_b32 v8, v92 offset:288
v_cvt_pk_bf16_f32 v93, v62, -v63
ds_write_b32 v8, v93 offset:576
v_pk_mul_f32 v[90:91], v[62:63], v[42:43] op_sel:[0,0] op_sel_hi:[1,0]
v_pk_fma_f32 v[90:91], v[62:63], v[42:43], v[90:91] op_sel:[1,1,0] op_sel_hi:[0,1,1] neg_lo:[0,1,0]
v_cvt_pk_bf16_f32 v94, v90, -v91
ds_write_b32 v8, v94 offset:864
v_pk_mul_f32 v[88:89], v[58:59], v[42:43] op_sel:[0,0] op_sel_hi:[1,0]
v_pk_fma_f32 v[88:89], v[58:59], v[42:43], v[88:89] op_sel:[1,1,0] op_sel_hi:[0,1,1] neg_lo:[0,1,0]
v_cvt_pk_bf16_f32 v95, v88, -v89
ds_write_b32 v8, v95 offset:1152
v_pk_mul_f32 v[90:91], v[58:59], v[46:47] op_sel:[0,0] op_sel_hi:[1,0]
v_pk_fma_f32 v[90:91], v[58:59], v[46:47], v[90:91] op_sel:[1,1,0] op_sel_hi:[0,1,1] neg_lo:[0,1,0]
v_cvt_pk_bf16_f32 v92, v90, -v91
ds_write_b32 v8, v92 offset:1440
v_cvt_pk_bf16_f32 v93, v64, -v65
ds_write_b32 v8, v93 offset:1728
v_pk_mul_f32 v[88:89], v[64:65], v[42:43] op_sel:[0,0] op_sel_hi:[1,0]
v_pk_fma_f32 v[88:89], v[64:65], v[42:43], v[88:89] op_sel:[1,1,0] op_sel_hi:[0,1,1] neg_lo:[0,1,0]
v_cvt_pk_bf16_f32 v94, v88, -v89
ds_write_b32 v8, v94 offset:2016
v_cvt_pk_bf16_f32 v95, v60, -v61
ds_write_b32 v8, v95 offset:2304
v_pk_mul_f32 v[90:91], v[60:61], v[38:39] op_sel:[0,0] op_sel_hi:[1,0]
v_pk_fma_f32 v[90:91], v[60:61], v[38:39], v[90:91] op_sel:[1,1,0] op_sel_hi:[0,1,1] neg_lo:[0,1,0]
v_cvt_pk_bf16_f32 v92, v90, -v91
ds_write_b32 v8, v92 offset:2592
v_cvt_pk_bf16_f32 v93, v66, -v67
ds_write_b32 v8, v93 offset:2880
v_pk_mul_f32 v[88:89], v[66:67], v[42:43] op_sel:[0,0] op_sel_hi:[1,0]
v_pk_fma_f32 v[88:89], v[66:67], v[42:43], v[88:89] op_sel:[1,1,0] op_sel_hi:[0,1,1] neg_lo:[0,1,0]
v_cvt_pk_bf16_f32 v94, v88, -v89
ds_write_b32 v8, v94 offset:3168
v_pk_mul_f32 v[90:91], v[60:61], v[42:43] op_sel:[0,0] op_sel_hi:[1,0]
v_pk_fma_f32 v[90:91], v[60:61], v[42:43], v[90:91] op_sel:[1,1,0] op_sel_hi:[0,1,1] neg_lo:[0,1,0]
v_cvt_pk_bf16_f32 v95, v90, -v91
ds_write_b32 v8, v95 offset:3456
v_pk_mul_f32 v[88:89], v[60:61], v[46:47] op_sel:[0,0] op_sel_hi:[1,0]
v_pk_fma_f32 v[88:89], v[60:61], v[46:47], v[88:89] op_sel:[1,1,0] op_sel_hi:[0,1,1] neg_lo:[0,1,0]
v_cvt_pk_bf16_f32 v92, v88, -v89
ds_write_b32 v8, v92 offset:3744
v_cvt_pk_bf16_f32 v93, v68, -v69
ds_write_b32 v8, v93 offset:4032
v_pk_mul_f32 v[90:91], v[68:69], v[42:43] op_sel:[0,0] op_sel_hi:[1,0]
v_pk_fma_f32 v[90:91], v[68:69], v[42:43], v[90:91] op_sel:[1,1,0] op_sel_hi:[0,1,1] neg_lo:[0,1,0]
v_cvt_pk_bf16_f32 v94, v90, -v91
ds_write_b32 v8, v94 offset:4320
s_waitcnt lgkmcnt(15)
v_mfma_f32_16x16x32_bf16 v[144:147], v[112:115], v[96:99], 0
v_mfma_f32_16x16x32_bf16 v[144:147], v[116:119], v[100:103], v[144:147]
v_mfma_f32_16x16x32_bf16 v[144:147], v[120:123], v[104:107], v[144:147]
v_mfma_f32_16x16x32_bf16 v[144:147], v[124:127], v[108:111], v[144:147]
ds_read_b128 v[128:131], v9 offset:0
ds_read_b128 v[132:135], v9 offset:64
ds_read_b128 v[136:139], v9 offset:128
ds_read_b128 v[140:143], v9 offset:192
buffer_load_dwordx2 v[206:207], v214, s[52:55], s83 offen offset:3072
v_cvt_pk_bf16_f32 v95, v70, -v71
ds_write_b32 v8, v95 offset:0
v_cvt_pk_bf16_f32 v92, v78, -v79
ds_write_b32 v8, v92 offset:288
v_cvt_pk_bf16_f32 v93, v86, -v87
ds_write_b32 v8, v93 offset:576
v_cvt_pk_bf16_f32 v94, v72, -v73
ds_write_b32 v8, v94 offset:1152
v_cvt_pk_bf16_f32 v95, v80, -v81
ds_write_b32 v8, v95 offset:1440
v_cvt_pk_bf16_f32 v92, v74, -v75
ds_write_b32 v8, v92 offset:2304
v_cvt_pk_bf16_f32 v93, v82, -v83
ds_write_b32 v8, v93 offset:2592
v_cvt_pk_bf16_f32 v94, v76, -v77
ds_write_b32 v8, v94 offset:3456
v_cvt_pk_bf16_f32 v95, v84, -v85
ds_write_b32 v8, v95 offset:3744
s_waitcnt lgkmcnt(9)
v_mfma_f32_16x16x32_bf16 v[148:151], v[128:131], v[96:99], 0
v_mfma_f32_16x16x32_bf16 v[148:151], v[132:135], v[100:103], v[148:151]
v_mfma_f32_16x16x32_bf16 v[148:151], v[136:139], v[104:107], v[148:151]
v_mfma_f32_16x16x32_bf16 v[148:151], v[140:143], v[108:111], v[148:151]
ds_read_b128 v[112:115], v9 offset:0
ds_read_b128 v[116:119], v9 offset:64
ds_read_b128 v[120:123], v9 offset:128
ds_read_b128 v[124:127], v9 offset:192
s_xor_b32 s76, s3, 1
s_mul_i32 s76, s76, 3072
s_add_u32 s76, s76, 88704
v_add_u32 v10, s76, v6
s_mul_i32 s76, s3, 3072
s_add_u32 s76, s76, 88704
v_add_u32 v11, s76, v6
s_mul_i32 s78, s3, 4176
s_add_u32 s78, s78, 16
s_lshl_b32 s76, s7, 1
s_sub_u32 s79, s78, s76
v_lshlrev_b32 v12, 4, v2
v_lshrrev_b32 v13, 1, v3
v_lshlrev_b32 v13, 8, v13
v_and_b32 v14, 1, v3
v_lshl_add_u32 v13, v14, 3, v13
v_add_u32 v13, v13, v12
s_add_u32 s76, s79, 3578
v_sub_u32 v13, s76, v13
v_lshl_add_u32 v14, v3, 8, v12
s_add_u32 s76, s79, 1014
v_sub_u32 v14, s76, v14
v_and_b32 v12, 1, v2
v_lshlrev_b32 v12, 1, v12
v_add_u32 v15, v14, v12
v_sub_u32 v18, v14, v12
v_lshl_add_u32 v12, v1, 2, s78
v_mov_b32 v19, s79
s_waitcnt lgkmcnt(0)
v_mfma_f32_16x16x32_bf16 v[152:155], v[112:115], v[96:99], 0
v_mfma_f32_16x16x32_bf16 v[152:155], v[116:119], v[100:103], v[152:155]
v_mfma_f32_16x16x32_bf16 v[152:155], v[120:123], v[104:107], v[152:155]
v_mfma_f32_16x16x32_bf16 v[152:155], v[124:127], v[108:111], v[152:155]
s_mov_b64 exec, 0x1ffff
ds_write_b32 v12, v16 offset:4092
s_mov_b64 exec, -1
ds_write_b128 v10, v[144:147] offset:0
ds_write_b128 v10, v[148:151] offset:1024
s_nop 2
ds_write_b128 v10, v[152:155] offset:2048
s_waitcnt lgkmcnt(0)
s_barrier
ds_read_b128 v[96:99], v11 offset:0
ds_read_b128 v[100:103], v11 offset:1024
ds_read_b128 v[104:107], v11 offset:2048
s_waitcnt lgkmcnt(0)
v_pk_add_f32 v[144:145], v[144:145], v[96:97]
v_pk_add_f32 v[146:147], v[146:147], v[98:99]
v_pk_add_f32 v[148:149], v[148:149], v[100:101]
v_pk_add_f32 v[150:151], v[150:151], v[102:103]
v_pk_add_f32 v[152:153], v[152:153], v[104:105]
v_pk_add_f32 v[154:155], v[154:155], v[106:107]
v_cvt_pk_bf16_f32 v96, v144, v145
v_cvt_pk_bf16_f32 v97, v146, v147
v_cvt_pk_bf16_f32 v98, v148, v149
v_cvt_pk_bf16_f32 v99, v150, v151
v_cvt_pk_bf16_f32 v100, v152, v153
v_cvt_pk_bf16_f32 v101, v154, v155
s_mov_b64 exec, 1
ds_write_b16 v19, v101 offset:0
ds_write_b16 v19, v101 offset:2
ds_write_b16 v19, v101 offset:4
ds_write_b16 v19, v101 offset:6
s_mov_b64 exec, -1
ds_write_b16_d16_hi v18, v100 offset:16
ds_write_b16_d16_hi v14, v100 offset:14
ds_write_b16_d16_hi v14, v100 offset:12
ds_write_b16_d16_hi v14, v100 offset:10
ds_write_b16_d16_hi v14, v100 offset:8
ds_write_b16_d16_hi v14, v100 offset:6
ds_write_b16_d16_hi v14, v100 offset:4
ds_write_b16_d16_hi v14, v100 offset:2
ds_write_b16_d16_hi v15, v100 offset:0
ds_write_b16 v18, v100 offset:1040
ds_write_b16 v14, v100 offset:1038
ds_write_b16 v14, v100 offset:1036
ds_write_b16 v14, v100 offset:1034
ds_write_b16 v14, v100 offset:1032
ds_write_b16 v14, v100 offset:1030
ds_write_b16 v14, v100 offset:1028
ds_write_b16 v14, v100 offset:1026
ds_write_b16 v15, v100 offset:1024
ds_write_b16 v14, v99 offset:2060
ds_write_b16 v14, v99 offset:2058
ds_write_b16 v14, v99 offset:2056
ds_write_b16 v14, v99 offset:2054
ds_write_b16 v14, v99 offset:2052
ds_write_b16_d16_hi v14, v99 offset:2050
ds_write_b16_d16_hi v14, v99 offset:2048
ds_write_b16_d16_hi v14, v99 offset:2046
ds_write_b16 v13, v98 offset:6
ds_write_b16 v13, v98 offset:4
ds_write_b16 v13, v98 offset:2
ds_write_b16_d16_hi v13, v98 offset:0
ds_write_b16 v13, v96 offset:516
ds_write_b16_d16_hi v13, v96 offset:514
ds_write_b16 v13, v97 offset:512
ds_write_b16_d16_hi v13, v97 offset:510
s_mul_i32 s80, s6, 4608
s_add_u32 s80, s80, 33408
v_add_u32 v13, s80, v6
v_mov_b32 v104, 0
v_mov_b32 v105, 0
v_mov_b32 v106, 0
v_mov_b32 v107, 0
s_mov_b32 exec_hi, 0
ds_write_b128 v13, v[104:107]
s_mov_b64 exec, -1
v_lshlrev_b32 v12, 3, v7
v_add_u32 v12, 33920, v12
s_mov_b32 s76, 0x05040100
s_mov_b32 s77, 0x07060302
s_waitcnt vmcnt(0)
v_perm_b32 v108, v202, v200, s76
v_perm_b32 v109, v206, v204, s76
ds_write_b64 v12, v[108:109] offset:0
v_perm_b32 v110, v202, v200, s77
v_perm_b32 v111, v206, v204, s77
ds_write_b64 v12, v[110:111] offset:4608
v_perm_b32 v112, v203, v201, s76
v_perm_b32 v113, v207, v205, s76
ds_write_b64 v12, v[112:113] offset:9216
v_perm_b32 v114, v203, v201, s77
v_perm_b32 v115, v207, v205, s77
ds_write_b64 v12, v[114:115] offset:13824
s_lshl_b32 s76, s6, 1
s_mul_i32 s76, s76, 4176
s_add_u32 s76, s76, 3118
v_and_b32 v12, 1, v2
v_xor_b32 v12, 1, v12
v_mul_u32_u24 v13, 4174, v12
v_lshl_add_u32 v13, v3, 4, v13
v_lshlrev_b32 v12, 1, v2
v_sub_u32 v13, v13, v12
v_add_u32 v8, s76, v13
v_add_u32 v9, -1024, v8
v_add_u32 v10, -2048, v8
v_add_u32 v11, -3072, v8
v_lshlrev_b32 v12, 5, v2
v_lshl_add_u32 v12, v3, 4, v12
s_add_u32 s76, s80, 32
v_add_u32 v14, s76, v12
v_lshlrev_b32 v12, 5, v2
v_lshl_add_u32 v12, v3, 3, v12
s_add_u32 s76, s80, 512
v_add_u32 v15, s76, v12
s_lshl_b32 s76, s6, 12
s_add_u32 s76, s76, 113280
v_add_u32 v17, s76, v12
s_waitcnt lgkmcnt(0)
s_barrier
s_cmp_lg_u32 s7, 0
s_cbranch_scc1 L_B_conv1
ds_read2_b32 v[64:65], v8 offset0:240 offset1:241
ds_read2_b32 v[66:67], v8 offset0:242 offset1:243
ds_read_b128 v[96:99], v14 offset:448
ds_read2_b32 v[68:69], v8 offset0:112 offset1:113
ds_read2_b32 v[70:71], v8 offset0:114 offset1:115
ds_read_b128 v[100:103], v14 offset:960
ds_read2_b32 v[72:73], v9 offset0:240 offset1:241
ds_read2_b32 v[74:75], v9 offset0:242 offset1:243
ds_read_b128 v[104:107], v14 offset:1472
ds_read2_b32 v[76:77], v9 offset0:112 offset1:113
ds_read2_b32 v[78:79], v9 offset0:114 offset1:115
ds_read_b128 v[108:111], v14 offset:1984
ds_read2_b32 v[80:81], v10 offset0:240 offset1:241
ds_read2_b32 v[82:83], v10 offset0:242 offset1:243
ds_read_b128 v[112:115], v14 offset:2496
ds_read2_b32 v[84:85], v10 offset0:112 offset1:113
ds_read2_b32 v[86:87], v10 offset0:114 offset1:115
ds_read_b128 v[116:119], v14 offset:3008
ds_read2_b32 v[88:89], v11 offset0:240 offset1:241
ds_read2_b32 v[90:91], v11 offset0:242 offset1:243
ds_read_b128 v[120:123], v14 offset:3520
ds_read2_b32 v[92:93], v11 offset0:112 offset1:113
ds_read2_b32 v[94:95], v11 offset0:114 offset1:115
ds_read_b128 v[124:127], v14 offset:4032
s_waitcnt lgkmcnt(0)
v_mfma_f32_16x16x32_bf16 v[32:35], v[64:67], v[120:123], 0
ds_read2_b32 v[128:129], v8 offset0:224 offset1:225
ds_read2_b32 v[130:131], v8 offset0:226 offset1:227
v_mfma_f32_16x16x32_bf16 v[36:39], v[64:67], v[124:127], 0
ds_read_b128 v[160:163], v14 offset:384
ds_read2_b32 v[132:133], v8 offset0:96 offset1:97
v_mfma_f32_16x16x32_bf16 v[40:43], v[64:67], v[96:99], 0
ds_read2_b32 v[134:135], v8 offset0:98 offset1:99
ds_read_b128 v[164:167], v14 offset:896
v_mfma_f32_16x16x32_bf16 v[44:47], v[64:67], v[100:103], 0
ds_read2_b32 v[136:137], v9 offset0:224 offset1:225
ds_read2_b32 v[138:139], v9 offset0:226 offset1:227
v_mfma_f32_16x16x32_bf16 v[32:35], v[68:71], v[116:119], v[32:35]
ds_read_b128 v[168:171], v14 offset:1408
ds_read2_b32 v[140:141], v9 offset0:96 offset1:97
v_mfma_f32_16x16x32_bf16 v[36:39], v[68:71], v[120:123], v[36:39]
ds_read2_b32 v[142:143], v9 offset0:98 offset1:99
ds_read_b128 v[172:175], v14 offset:1920
v_mfma_f32_16x16x32_bf16 v[44:47], v[68:71], v[96:99], v[44:47]
ds_read2_b32 v[144:145], v10 offset0:224 offset1:225
ds_read2_b32 v[146:147], v10 offset0:226 offset1:227
v_mfma_f32_16x16x32_bf16 v[32:35], v[72:75], v[112:115], v[32:35]
ds_read_b128 v[176:179], v14 offset:2432
ds_read2_b32 v[148:149], v10 offset0:96 offset1:97
v_mfma_f32_16x16x32_bf16 v[36:39], v[72:75], v[116:119], v[36:39]
ds_read2_b32 v[150:151], v10 offset0:98 offset1:99
ds_read_b128 v[180:183], v14 offset:2944
v_mfma_f32_16x16x32_bf16 v[32:35], v[76:79], v[108:111], v[32:35]
ds_read2_b32 v[152:153], v11 offset0:224 offset1:225
ds_read2_b32 v[154:155], v11 offset0:226 offset1:227
v_mfma_f32_16x16x32_bf16 v[36:39], v[76:79], v[112:115], v[36:39]
ds_read_b128 v[184:187], v14 offset:3456
ds_read2_b32 v[156:157], v11 offset0:96 offset1:97
v_mfma_f32_16x16x32_bf16 v[32:35], v[80:83], v[104:107], v[32:35]
ds_read2_b32 v[158:159], v11 offset0:98 offset1:99
ds_read_b128 v[188:191], v14 offset:3968
v_mfma_f32_16x16x32_bf16 v[36:39], v[80:83], v[108:111], v[36:39]
v_mfma_f32_16x16x32_bf16 v[32:35], v[84:87], v[100:103], v[32:35]
v_mfma_f32_16x16x32_bf16 v[36:39], v[84:87], v[104:107], v[36:39]
v_mfma_f32_16x16x32_bf16 v[32:35], v[88:91], v[96:99], v[32:35]
v_mfma_f32_16x16x32_bf16 v[36:39], v[88:91], v[100:103], v[36:39]
v_mfma_f32_16x16x32_bf16 v[36:39], v[92:95], v[96:99], v[36:39]
s_waitcnt lgkmcnt(0)
v_mfma_f32_16x16x32_bf16 v[32:35], v[128:131], v[184:187], v[32:35]
ds_read2_b32 v[64:65], v8 offset0:208 offset1:209
ds_read2_b32 v[66:67], v8 offset0:210 offset1:211
v_mfma_f32_16x16x32_bf16 v[36:39], v[128:131], v[188:191], v[36:39]
ds_read_b128 v[96:99], v14 offset:320
ds_read2_b32 v[68:69], v8 offset0:80 offset1:81
v_mfma_f32_16x16x32_bf16 v[40:43], v[128:131], v[160:163], v[40:43]
ds_read2_b32 v[70:71], v8 offset0:82 offset1:83
ds_read_b128 v[100:103], v14 offset:832
v_mfma_f32_16x16x32_bf16 v[44:47], v[128:131], v[164:167], v[44:47]
ds_read2_b32 v[72:73], v9 offset0:208 offset1:209
ds_read2_b32 v[74:75], v9 offset0:210 offset1:211
v_mfma_f32_16x16x32_bf16 v[32:35], v[132:135], v[180:183], v[32:35]
ds_read_b128 v[104:107], v14 offset:1344
ds_read2_b32 v[76:77], v9 offset0:80 offset1:81
v_mfma_f32_16x16x32_bf16 v[36:39], v[132:135], v[184:187], v[36:39]
ds_read2_b32 v[78:79], v9 offset0:82 offset1:83
ds_read_b128 v[108:111], v14 offset:1856
v_mfma_f32_16x16x32_bf16 v[44:47], v[132:135], v[160:163], v[44:47]
ds_read2_b32 v[80:81], v10 offset0:208 offset1:209
ds_read2_b32 v[82:83], v10 offset0:210 offset1:211
v_mfma_f32_16x16x32_bf16 v[32:35], v[136:139], v[176:179], v[32:35]
ds_read_b128 v[112:115], v14 offset:2368
ds_read2_b32 v[84:85], v10 offset0:80 offset1:81
v_mfma_f32_16x16x32_bf16 v[36:39], v[136:139], v[180:183], v[36:39]
ds_read2_b32 v[86:87], v10 offset0:82 offset1:83
ds_read_b128 v[116:119], v14 offset:2880
v_mfma_f32_16x16x32_bf16 v[32:35], v[140:143], v[172:175], v[32:35]
ds_read2_b32 v[88:89], v11 offset0:208 offset1:209
ds_read2_b32 v[90:91], v11 offset0:210 offset1:211
v_mfma_f32_16x16x32_bf16 v[36:39], v[140:143], v[176:179], v[36:39]
ds_read_b128 v[120:123], v14 offset:3392
ds_read2_b32 v[92:93], v11 offset0:80 offset1:81
v_mfma_f32_16x16x32_bf16 v[32:35], v[144:147], v[168:171], v[32:35]
ds_read2_b32 v[94:95], v11 offset0:82 offset1:83
ds_read_b128 v[124:127], v14 offset:3904
v_mfma_f32_16x16x32_bf16 v[36:39], v[144:147], v[172:175], v[36:39]
v_mfma_f32_16x16x32_bf16 v[32:35], v[148:151], v[164:167], v[32:35]
v_mfma_f32_16x16x32_bf16 v[36:39], v[148:151], v[168:171], v[36:39]
v_mfma_f32_16x16x32_bf16 v[32:35], v[152:155], v[160:163], v[32:35]
v_mfma_f32_16x16x32_bf16 v[36:39], v[152:155], v[164:167], v[36:39]
v_mfma_f32_16x16x32_bf16 v[36:39], v[156:159], v[160:163], v[36:39]
s_waitcnt lgkmcnt(0)
v_mfma_f32_16x16x32_bf16 v[32:35], v[64:67], v[120:123], v[32:35]
ds_read2_b32 v[128:129], v8 offset0:192 offset1:193
ds_read2_b32 v[130:131], v8 offset0:194 offset1:195
v_mfma_f32_16x16x32_bf16 v[36:39], v[64:67], v[124:127], v[36:39]
ds_read_b128 v[160:163], v14 offset:256
ds_read2_b32 v[132:133], v8 offset0:64 offset1:65
v_mfma_f32_16x16x32_bf16 v[40:43], v[64:67], v[96:99], v[40:43]
ds_read2_b32 v[134:135], v8 offset0:66 offset1:67
ds_read_b128 v[164:167], v14 offset:768
v_mfma_f32_16x16x32_bf16 v[44:47], v[64:67], v[100:103], v[44:47]
ds_read2_b32 v[136:137], v9 offset0:192 offset1:193
ds_read2_b32 v[138:139], v9 offset0:194 offset1:195
v_mfma_f32_16x16x32_bf16 v[32:35], v[68:71], v[116:119], v[32:35]
ds_read_b128 v[168:171], v14 offset:1280
ds_read2_b32 v[140:141], v9 offset0:64 offset1:65
v_mfma_f32_16x16x32_bf16 v[36:39], v[68:71], v[120:123], v[36:39]
ds_read2_b32 v[142:143], v9 offset0:66 offset1:67
ds_read_b128 v[172:175], v14 offset:1792
v_mfma_f32_16x16x32_bf16 v[44:47], v[68:71], v[96:99], v[44:47]
ds_read2_b32 v[144:145], v10 offset0:192 offset1:193
ds_read2_b32 v[146:147], v10 offset0:194 offset1:195
v_mfma_f32_16x16x32_bf16 v[32:35], v[72:75], v[112:115], v[32:35]
ds_read_b128 v[176:179], v14 offset:2304
ds_read2_b32 v[148:149], v10 offset0:64 offset1:65
v_mfma_f32_16x16x32_bf16 v[36:39], v[72:75], v[116:119], v[36:39]
ds_read2_b32 v[150:151], v10 offset0:66 offset1:67
ds_read_b128 v[180:183], v14 offset:2816
v_mfma_f32_16x16x32_bf16 v[32:35], v[76:79], v[108:111], v[32:35]
ds_read2_b32 v[152:153], v11 offset0:192 offset1:193
ds_read2_b32 v[154:155], v11 offset0:194 offset1:195
v_mfma_f32_16x16x32_bf16 v[36:39], v[76:79], v[112:115], v[36:39]
ds_read_b128 v[184:187], v14 offset:3328
ds_read2_b32 v[156:157], v11 offset0:64 offset1:65
v_mfma_f32_16x16x32_bf16 v[32:35], v[80:83], v[104:107], v[32:35]
ds_read2_b32 v[158:159], v11 offset0:66 offset1:67
ds_read_b128 v[188:191], v14 offset:3840
v_mfma_f32_16x16x32_bf16 v[36:39], v[80:83], v[108:111], v[36:39]
v_mfma_f32_16x16x32_bf16 v[32:35], v[84:87], v[100:103], v[32:35]
v_mfma_f32_16x16x32_bf16 v[36:39], v[84:87], v[104:107], v[36:39]
v_mfma_f32_16x16x32_bf16 v[32:35], v[88:91], v[96:99], v[32:35]
v_mfma_f32_16x16x32_bf16 v[36:39], v[88:91], v[100:103], v[36:39]
v_mfma_f32_16x16x32_bf16 v[36:39], v[92:95], v[96:99], v[36:39]
s_waitcnt lgkmcnt(0)
v_mfma_f32_16x16x32_bf16 v[32:35], v[128:131], v[184:187], v[32:35]
ds_read2_b32 v[64:65], v8 offset0:176 offset1:177
ds_read2_b32 v[66:67], v8 offset0:178 offset1:179
v_mfma_f32_16x16x32_bf16 v[36:39], v[128:131], v[188:191], v[36:39]
ds_read_b128 v[96:99], v14 offset:192
ds_read2_b32 v[68:69], v8 offset0:48 offset1:49
v_mfma_f32_16x16x32_bf16 v[40:43], v[128:131], v[160:163], v[40:43]
ds_read2_b32 v[70:71], v8 offset0:50 offset1:51
ds_read_b128 v[100:103], v14 offset:704
v_mfma_f32_16x16x32_bf16 v[44:47], v[128:131], v[164:167], v[44:47]
ds_read2_b32 v[72:73], v9 offset0:176 offset1:177
ds_read2_b32 v[74:75], v9 offset0:178 offset1:179
v_mfma_f32_16x16x32_bf16 v[32:35], v[132:135], v[180:183], v[32:35]
ds_read_b128 v[104:107], v14 offset:1216
ds_read2_b32 v[76:77], v9 offset0:48 offset1:49
v_mfma_f32_16x16x32_bf16 v[36:39], v[132:135], v[184:187], v[36:39]
ds_read2_b32 v[78:79], v9 offset0:50 offset1:51
ds_read_b128 v[108:111], v14 offset:1728
v_mfma_f32_16x16x32_bf16 v[44:47], v[132:135], v[160:163], v[44:47]
ds_read2_b32 v[80:81], v10 offset0:176 offset1:177
ds_read2_b32 v[82:83], v10 offset0:178 offset1:179
v_mfma_f32_16x16x32_bf16 v[32:35], v[136:139], v[176:179], v[32:35]
ds_read_b128 v[112:115], v14 offset:2240
ds_read2_b32 v[84:85], v10 offset0:48 offset1:49
v_mfma_f32_16x16x32_bf16 v[36:39], v[136:139], v[180:183], v[36:39]
ds_read2_b32 v[86:87], v10 offset0:50 offset1:51
ds_read_b128 v[116:119], v14 offset:2752
v_mfma_f32_16x16x32_bf16 v[32:35], v[140:143], v[172:175], v[32:35]
ds_read2_b32 v[88:89], v11 offset0:176 offset1:177
ds_read2_b32 v[90:91], v11 offset0:178 offset1:179
v_mfma_f32_16x16x32_bf16 v[36:39], v[140:143], v[176:179], v[36:39]
ds_read_b128 v[120:123], v14 offset:3264
ds_read2_b32 v[92:93], v11 offset0:48 offset1:49
v_mfma_f32_16x16x32_bf16 v[32:35], v[144:147], v[168:171], v[32:35]
ds_read2_b32 v[94:95], v11 offset0:50 offset1:51
ds_read_b128 v[124:127], v14 offset:3776
v_mfma_f32_16x16x32_bf16 v[36:39], v[144:147], v[172:175], v[36:39]
v_mfma_f32_16x16x32_bf16 v[32:35], v[148:151], v[164:167], v[32:35]
v_mfma_f32_16x16x32_bf16 v[36:39], v[148:151], v[168:171], v[36:39]
v_mfma_f32_16x16x32_bf16 v[32:35], v[152:155], v[160:163], v[32:35]
v_mfma_f32_16x16x32_bf16 v[36:39], v[152:155], v[164:167], v[36:39]
v_mfma_f32_16x16x32_bf16 v[36:39], v[156:159], v[160:163], v[36:39]
s_waitcnt lgkmcnt(0)
v_mfma_f32_16x16x32_bf16 v[32:35], v[64:67], v[120:123], v[32:35]
ds_read2_b32 v[128:129], v8 offset0:160 offset1:161
ds_read2_b32 v[130:131], v8 offset0:162 offset1:163
v_mfma_f32_16x16x32_bf16 v[36:39], v[64:67], v[124:127], v[36:39]
ds_read_b128 v[160:163], v14 offset:128
ds_read2_b32 v[132:133], v8 offset0:32 offset1:33
v_mfma_f32_16x16x32_bf16 v[40:43], v[64:67], v[96:99], v[40:43]
ds_read2_b32 v[134:135], v8 offset0:34 offset1:35
ds_read_b128 v[164:167], v14 offset:640
v_mfma_f32_16x16x32_bf16 v[44:47], v[64:67], v[100:103], v[44:47]
ds_read2_b32 v[136:137], v9 offset0:160 offset1:161
ds_read2_b32 v[138:139], v9 offset0:162 offset1:163
v_mfma_f32_16x16x32_bf16 v[32:35], v[68:71], v[116:119], v[32:35]
ds_read_b128 v[168:171], v14 offset:1152
ds_read2_b32 v[140:141], v9 offset0:32 offset1:33
v_mfma_f32_16x16x32_bf16 v[36:39], v[68:71], v[120:123], v[36:39]
ds_read2_b32 v[142:143], v9 offset0:34 offset1:35
ds_read_b128 v[172:175], v14 offset:1664
v_mfma_f32_16x16x32_bf16 v[44:47], v[68:71], v[96:99], v[44:47]
ds_read2_b32 v[144:145], v10 offset0:160 offset1:161
ds_read2_b32 v[146:147], v10 offset0:162 offset1:163
v_mfma_f32_16x16x32_bf16 v[32:35], v[72:75], v[112:115], v[32:35]
ds_read_b128 v[176:179], v14 offset:2176
ds_read2_b32 v[148:149], v10 offset0:32 offset1:33
v_mfma_f32_16x16x32_bf16 v[36:39], v[72:75], v[116:119], v[36:39]
ds_read2_b32 v[150:151], v10 offset0:34 offset1:35
ds_read_b128 v[180:183], v14 offset:2688
v_mfma_f32_16x16x32_bf16 v[32:35], v[76:79], v[108:111], v[32:35]
ds_read2_b32 v[152:153], v11 offset0:160 offset1:161
ds_read2_b32 v[154:155], v11 offset0:162 offset1:163
v_mfma_f32_16x16x32_bf16 v[36:39], v[76:79], v[112:115], v[36:39]
ds_read_b128 v[184:187], v14 offset:3200
ds_read2_b32 v[156:157], v11 offset0:32 offset1:33
v_mfma_f32_16x16x32_bf16 v[32:35], v[80:83], v[104:107], v[32:35]
ds_read2_b32 v[158:159], v11 offset0:34 offset1:35
ds_read_b128 v[188:191], v14 offset:3712
v_mfma_f32_16x16x32_bf16 v[36:39], v[80:83], v[108:111], v[36:39]
v_mfma_f32_16x16x32_bf16 v[32:35], v[84:87], v[100:103], v[32:35]
v_mfma_f32_16x16x32_bf16 v[36:39], v[84:87], v[104:107], v[36:39]
v_mfma_f32_16x16x32_bf16 v[32:35], v[88:91], v[96:99], v[32:35]
v_mfma_f32_16x16x32_bf16 v[36:39], v[88:91], v[100:103], v[36:39]
v_mfma_f32_16x16x32_bf16 v[36:39], v[92:95], v[96:99], v[36:39]
s_waitcnt lgkmcnt(0)
v_mfma_f32_16x16x32_bf16 v[32:35], v[128:131], v[184:187], v[32:35]
ds_read2_b32 v[64:65], v8 offset0:144 offset1:145
ds_read2_b32 v[66:67], v8 offset0:146 offset1:147
v_mfma_f32_16x16x32_bf16 v[36:39], v[128:131], v[188:191], v[36:39]
ds_read_b128 v[96:99], v14 offset:64
ds_read2_b32 v[68:69], v8 offset0:16 offset1:17
v_mfma_f32_16x16x32_bf16 v[40:43], v[128:131], v[160:163], v[40:43]
ds_read2_b32 v[70:71], v8 offset0:18 offset1:19
ds_read_b128 v[100:103], v14 offset:576
v_mfma_f32_16x16x32_bf16 v[44:47], v[128:131], v[164:167], v[44:47]
ds_read2_b32 v[72:73], v9 offset0:144 offset1:145
ds_read2_b32 v[74:75], v9 offset0:146 offset1:147
v_mfma_f32_16x16x32_bf16 v[32:35], v[132:135], v[180:183], v[32:35]
ds_read_b128 v[104:107], v14 offset:1088
ds_read2_b32 v[76:77], v9 offset0:16 offset1:17
v_mfma_f32_16x16x32_bf16 v[36:39], v[132:135], v[184:187], v[36:39]
ds_read2_b32 v[78:79], v9 offset0:18 offset1:19
ds_read_b128 v[108:111], v14 offset:1600
v_mfma_f32_16x16x32_bf16 v[44:47], v[132:135], v[160:163], v[44:47]
ds_read2_b32 v[80:81], v10 offset0:144 offset1:145
ds_read2_b32 v[82:83], v10 offset0:146 offset1:147
v_mfma_f32_16x16x32_bf16 v[32:35], v[136:139], v[176:179], v[32:35]
ds_read_b128 v[112:115], v14 offset:2112
ds_read2_b32 v[84:85], v10 offset0:16 offset1:17
v_mfma_f32_16x16x32_bf16 v[36:39], v[136:139], v[180:183], v[36:39]
ds_read2_b32 v[86:87], v10 offset0:18 offset1:19
ds_read_b128 v[116:119], v14 offset:2624
v_mfma_f32_16x16x32_bf16 v[32:35], v[140:143], v[172:175], v[32:35]
ds_read2_b32 v[88:89], v11 offset0:144 offset1:145
ds_read2_b32 v[90:91], v11 offset0:146 offset1:147
v_mfma_f32_16x16x32_bf16 v[36:39], v[140:143], v[176:179], v[36:39]
ds_read_b128 v[120:123], v14 offset:3136
ds_read2_b32 v[92:93], v11 offset0:16 offset1:17
v_mfma_f32_16x16x32_bf16 v[32:35], v[144:147], v[168:171], v[32:35]
ds_read2_b32 v[94:95], v11 offset0:18 offset1:19
ds_read_b128 v[124:127], v14 offset:3648
v_mfma_f32_16x16x32_bf16 v[36:39], v[144:147], v[172:175], v[36:39]
v_mfma_f32_16x16x32_bf16 v[32:35], v[148:151], v[164:167], v[32:35]
v_mfma_f32_16x16x32_bf16 v[36:39], v[148:151], v[168:171], v[36:39]
v_mfma_f32_16x16x32_bf16 v[32:35], v[152:155], v[160:163], v[32:35]
v_mfma_f32_16x16x32_bf16 v[36:39], v[152:155], v[164:167], v[36:39]
v_mfma_f32_16x16x32_bf16 v[36:39], v[156:159], v[160:163], v[36:39]
s_waitcnt lgkmcnt(0)
v_mfma_f32_16x16x32_bf16 v[32:35], v[64:67], v[120:123], v[32:35]
ds_read2_b32 v[128:129], v8 offset0:128 offset1:129
ds_read2_b32 v[130:131], v8 offset0:130 offset1:131
v_mfma_f32_16x16x32_bf16 v[36:39], v[64:67], v[124:127], v[36:39]
ds_read_b128 v[160:163], v14 offset:0
ds_read2_b32 v[132:133], v8 offset0:0 offset1:1
v_mfma_f32_16x16x32_bf16 v[40:43], v[64:67], v[96:99], v[40:43]
ds_read2_b32 v[134:135], v8 offset0:2 offset1:3
ds_read_b128 v[164:167], v14 offset:512
v_mfma_f32_16x16x32_bf16 v[44:47], v[64:67], v[100:103], v[44:47]
ds_read2_b32 v[136:137], v9 offset0:128 offset1:129
ds_read2_b32 v[138:139], v9 offset0:130 offset1:131
v_mfma_f32_16x16x32_bf16 v[32:35], v[68:71], v[116:119], v[32:35]
ds_read_b128 v[168:171], v14 offset:1024
ds_read2_b32 v[140:141], v9 offset0:0 offset1:1
v_mfma_f32_16x16x32_bf16 v[36:39], v[68:71], v[120:123], v[36:39]
ds_read2_b32 v[142:143], v9 offset0:2 offset1:3
ds_read_b128 v[172:175], v14 offset:1536
v_mfma_f32_16x16x32_bf16 v[44:47], v[68:71], v[96:99], v[44:47]
ds_read2_b32 v[144:145], v10 offset0:128 offset1:129
ds_read2_b32 v[146:147], v10 offset0:130 offset1:131
v_mfma_f32_16x16x32_bf16 v[32:35], v[72:75], v[112:115], v[32:35]
ds_read_b128 v[176:179], v14 offset:2048
ds_read2_b32 v[148:149], v10 offset0:0 offset1:1
v_mfma_f32_16x16x32_bf16 v[36:39], v[72:75], v[116:119], v[36:39]
ds_read2_b32 v[150:151], v10 offset0:2 offset1:3
ds_read_b128 v[180:183], v14 offset:2560
v_mfma_f32_16x16x32_bf16 v[32:35], v[76:79], v[108:111], v[32:35]
ds_read2_b32 v[152:153], v11 offset0:128 offset1:129
ds_read2_b32 v[154:155], v11 offset0:130 offset1:131
v_mfma_f32_16x16x32_bf16 v[36:39], v[76:79], v[112:115], v[36:39]
ds_read_b128 v[184:187], v14 offset:3072
ds_read2_b32 v[156:157], v11 offset0:0 offset1:1
v_mfma_f32_16x16x32_bf16 v[32:35], v[80:83], v[104:107], v[32:35]
ds_read2_b32 v[158:159], v11 offset0:2 offset1:3
ds_read_b128 v[188:191], v14 offset:3584
v_mfma_f32_16x16x32_bf16 v[36:39], v[80:83], v[108:111], v[36:39]
v_mfma_f32_16x16x32_bf16 v[32:35], v[84:87], v[100:103], v[32:35]
v_mfma_f32_16x16x32_bf16 v[36:39], v[84:87], v[104:107], v[36:39]
v_mfma_f32_16x16x32_bf16 v[32:35], v[88:91], v[96:99], v[32:35]
v_mfma_f32_16x16x32_bf16 v[36:39], v[88:91], v[100:103], v[36:39]
v_mfma_f32_16x16x32_bf16 v[36:39], v[92:95], v[96:99], v[36:39]
s_waitcnt lgkmcnt(0)
v_mfma_f32_16x16x32_bf16 v[32:35], v[128:131], v[184:187], v[32:35]
ds_read_b64 v[48:49], v15 offset:3072
ds_read_b64 v[50:51], v15 offset:3584
v_mfma_f32_16x16x32_bf16 v[36:39], v[128:131], v[188:191], v[36:39]
ds_read_b64 v[52:53], v15 offset:0
ds_read_b64 v[54:55], v15 offset:512
v_mfma_f32_16x16x32_bf16 v[40:43], v[128:131], v[160:163], v[40:43]
v_mfma_f32_16x16x32_bf16 v[44:47], v[128:131], v[164:167], v[44:47]
v_mfma_f32_16x16x32_bf16 v[32:35], v[132:135], v[180:183], v[32:35]
v_mfma_f32_16x16x32_bf16 v[36:39], v[132:135], v[184:187], v[36:39]
v_mfma_f32_16x16x32_bf16 v[44:47], v[132:135], v[160:163], v[44:47]
v_mfma_f32_16x16x32_bf16 v[32:35], v[136:139], v[176:179], v[32:35]
v_mfma_f32_16x16x32_bf16 v[36:39], v[136:139], v[180:183], v[36:39]
v_mfma_f32_16x16x32_bf16 v[32:35], v[140:143], v[172:175], v[32:35]
v_mfma_f32_16x16x32_bf16 v[36:39], v[140:143], v[176:179], v[36:39]
v_mfma_f32_16x16x32_bf16 v[32:35], v[144:147], v[168:171], v[32:35]
v_mfma_f32_16x16x32_bf16 v[36:39], v[144:147], v[172:175], v[36:39]
v_mfma_f32_16x16x32_bf16 v[32:35], v[148:151], v[164:167], v[32:35]
v_mfma_f32_16x16x32_bf16 v[36:39], v[148:151], v[168:171], v[36:39]
v_mfma_f32_16x16x32_bf16 v[32:35], v[152:155], v[160:163], v[32:35]
v_mfma_f32_16x16x32_bf16 v[36:39], v[152:155], v[164:167], v[36:39]
v_mfma_f32_16x16x32_bf16 v[36:39], v[156:159], v[160:163], v[36:39]
v_add_u32 v18, 3072, v17
s_branch L_B_conv2
L_B_conv1:
ds_read2_b32 v[64:65], v8 offset0:240 offset1:241
ds_read2_b32 v[66:67], v8 offset0:242 offset1:243
ds_read_b128 v[96:99], v14 offset:448
ds_read2_b32 v[68:69], v8 offset0:112 offset1:113
ds_read2_b32 v[70:71], v8 offset0:114 offset1:115
ds_read_b128 v[100:103], v14 offset:960
ds_read2_b32 v[72:73], v9 offset0:240 offset1:241
ds_read2_b32 v[74:75], v9 offset0:242 offset1:243
ds_read_b128 v[104:107], v14 offset:1472
ds_read2_b32 v[76:77], v9 offset0:112 offset1:113
ds_read2_b32 v[78:79], v9 offset0:114 offset1:115
ds_read_b128 v[108:111], v14 offset:1984
ds_read2_b32 v[80:81], v10 offset0:240 offset1:241
ds_read2_b32 v[82:83], v10 offset0:242 offset1:243
ds_read_b128 v[112:115], v14 offset:2496
ds_read2_b32 v[84:85], v10 offset0:112 offset1:113
ds_read2_b32 v[86:87], v10 offset0:114 offset1:115
ds_read_b128 v[116:119], v14 offset:3008
s_waitcnt lgkmcnt(0)
v_mfma_f32_16x16x32_bf16 v[32:35], v[64:67], v[112:115], 0
ds_read2_b32 v[128:129], v8 offset0:224 offset1:225
ds_read2_b32 v[130:131], v8 offset0:226 offset1:227
v_mfma_f32_16x16x32_bf16 v[36:39], v[64:67], v[116:119], 0
ds_read_b128 v[160:163], v14 offset:384
ds_read2_b32 v[132:133], v8 offset0:96 offset1:97
v_mfma_f32_16x16x32_bf16 v[40:43], v[64:67], v[104:107], 0
ds_read2_b32 v[134:135], v8 offset0:98 offset1:99
ds_read_b128 v[164:167], v14 offset:896
v_mfma_f32_16x16x32_bf16 v[44:47], v[64:67], v[108:111], 0
ds_read2_b32 v[136:137], v9 offset0:224 offset1:225
ds_read2_b32 v[138:139], v9 offset0:226 offset1:227
v_mfma_f32_16x16x32_bf16 v[32:35], v[68:71], v[108:111], v[32:35]
ds_read_b128 v[168:171], v14 offset:1408
ds_read2_b32 v[140:141], v9 offset0:96 offset1:97
v_mfma_f32_16x16x32_bf16 v[36:39], v[68:71], v[112:115], v[36:39]
ds_read2_b32 v[142:143], v9 offset0:98 offset1:99
ds_read_b128 v[172:175], v14 offset:1920
v_mfma_f32_16x16x32_bf16 v[40:43], v[68:71], v[100:103], v[40:43]
ds_read2_b32 v[144:145], v10 offset0:224 offset1:225
ds_read2_b32 v[146:147], v10 offset0:226 offset1:227
v_mfma_f32_16x16x32_bf16 v[44:47], v[68:71], v[104:107], v[44:47]
ds_read_b128 v[176:179], v14 offset:2432
ds_read2_b32 v[148:149], v10 offset0:96 offset1:97
v_mfma_f32_16x16x32_bf16 v[32:35], v[72:75], v[104:107], v[32:35]
ds_read2_b32 v[150:151], v10 offset0:98 offset1:99
ds_read_b128 v[180:183], v14 offset:2944
v_mfma_f32_16x16x32_bf16 v[36:39], v[72:75], v[108:111], v[36:39]
v_mfma_f32_16x16x32_bf16 v[40:43], v[72:75], v[96:99], v[40:43]
v_mfma_f32_16x16x32_bf16 v[44:47], v[72:75], v[100:103], v[44:47]
v_mfma_f32_16x16x32_bf16 v[32:35], v[76:79], v[100:103], v[32:35]
v_mfma_f32_16x16x32_bf16 v[36:39], v[76:79], v[104:107], v[36:39]
v_mfma_f32_16x16x32_bf16 v[44:47], v[76:79], v[96:99], v[44:47]
v_mfma_f32_16x16x32_bf16 v[32:35], v[80:83], v[96:99], v[32:35]
v_mfma_f32_16x16x32_bf16 v[36:39], v[80:83], v[100:103], v[36:39]
v_mfma_f32_16x16x32_bf16 v[36:39], v[84:87], v[96:99], v[36:39]
s_waitcnt lgkmcnt(0)
v_mfma_f32_16x16x32_bf16 v[32:35], v[128:131], v[176:179], v[32:35]
ds_read2_b32 v[64:65], v8 offset0:208 offset1:209
ds_read2_b32 v[66:67], v8 offset0:210 offset1:211
v_mfma_f32_16x16x32_bf16 v[36:39], v[128:131], v[180:183], v[36:39]
ds_read_b128 v[96:99], v14 offset:320
ds_read2_b32 v[68:69], v8 offset0:80 offset1:81
v_mfma_f32_16x16x32_bf16 v[40:43], v[128:131], v[168:171], v[40:43]
ds_read2_b32 v[70:71], v8 offset0:82 offset1:83
ds_read_b128 v[100:103], v14 offset:832
v_mfma_f32_16x16x32_bf16 v[44:47], v[128:131], v[172:175], v[44:47]
ds_read2_b32 v[72:73], v9 offset0:208 offset1:209
ds_read2_b32 v[74:75], v9 offset0:210 offset1:211
v_mfma_f32_16x16x32_bf16 v[32:35], v[132:135], v[172:175], v[32:35]
ds_read_b128 v[104:107], v14 offset:1344
ds_read2_b32 v[76:77], v9 offset0:80 offset1:81
v_mfma_f32_16x16x32_bf16 v[36:39], v[132:135], v[176:179], v[36:39]
ds_read2_b32 v[78:79], v9 offset0:82 offset1:83
ds_read_b128 v[108:111], v14 offset:1856
v_mfma_f32_16x16x32_bf16 v[40:43], v[132:135], v[164:167], v[40:43]
ds_read2_b32 v[80:81], v10 offset0:208 offset1:209
ds_read2_b32 v[82:83], v10 offset0:210 offset1:211
v_mfma_f32_16x16x32_bf16 v[44:47], v[132:135], v[168:171], v[44:47]
ds_read_b128 v[112:115], v14 offset:2368
ds_read2_b32 v[84:85], v10 offset0:80 offset1:81
v_mfma_f32_16x16x32_bf16 v[32:35], v[136:139], v[168:171], v[32:35]
ds_read2_b32 v[86:87], v10 offset0:82 offset1:83
ds_read_b128 v[116:119], v14 offset:2880
v_mfma_f32_16x16x32_bf16 v[36:39], v[136:139], v[172:175], v[36:39]
v_mfma_f32_16x16x32_bf16 v[40:43], v[136:139], v[160:163], v[40:43]
v_mfma_f32_16x16x32_bf16 v[44:47], v[136:139], v[164:167], v[44:47]
v_mfma_f32_16x16x32_bf16 v[32:35], v[140:143], v[164:167], v[32:35]
v_mfma_f32_16x16x32_bf16 v[36:39], v[140:143], v[168:171], v[36:39]
v_mfma_f32_16x16x32_bf16 v[44:47], v[140:143], v[160:163], v[44:47]
v_mfma_f32_16x16x32_bf16 v[32:35], v[144:147], v[160:163], v[32:35]
v_mfma_f32_16x16x32_bf16 v[36:39], v[144:147], v[164:167], v[36:39]
v_mfma_f32_16x16x32_bf16 v[36:39], v[148:151], v[160:163], v[36:39]
s_waitcnt lgkmcnt(0)
v_mfma_f32_16x16x32_bf16 v[32:35], v[64:67], v[112:115], v[32:35]
ds_read2_b32 v[128:129], v8 offset0:192 offset1:193
ds_read2_b32 v[130:131], v8 offset0:194 offset1:195
v_mfma_f32_16x16x32_bf16 v[36:39], v[64:67], v[116:119], v[36:39]
ds_read_b128 v[160:163], v14 offset:256
ds_read2_b32 v[132:133], v8 offset0:64 offset1:65
v_mfma_f32_16x16x32_bf16 v[40:43], v[64:67], v[104:107], v[40:43]
ds_read2_b32 v[134:135], v8 offset0:66 offset1:67
ds_read_b128 v[164:167], v14 offset:768
v_mfma_f32_16x16x32_bf16 v[44:47], v[64:67], v[108:111], v[44:47]
ds_read2_b32 v[136:137], v9 offset0:192 offset1:193
ds_read2_b32 v[138:139], v9 offset0:194 offset1:195
v_mfma_f32_16x16x32_bf16 v[32:35], v[68:71], v[108:111], v[32:35]
ds_read_b128 v[168:171], v14 offset:1280
ds_read2_b32 v[140:141], v9 offset0:64 offset1:65
v_mfma_f32_16x16x32_bf16 v[36:39], v[68:71], v[112:115], v[36:39]
ds_read2_b32 v[142:143], v9 offset0:66 offset1:67
ds_read_b128 v[172:175], v14 offset:1792
v_mfma_f32_16x16x32_bf16 v[40:43], v[68:71], v[100:103], v[40:43]
ds_read2_b32 v[144:145], v10 offset0:192 offset1:193
ds_read2_b32 v[146:147], v10 offset0:194 offset1:195
v_mfma_f32_16x16x32_bf16 v[44:47], v[68:71], v[104:107], v[44:47]
ds_read_b128 v[176:179], v14 offset:2304
ds_read2_b32 v[148:149], v10 offset0:64 offset1:65
v_mfma_f32_16x16x32_bf16 v[32:35], v[72:75], v[104:107], v[32:35]
ds_read2_b32 v[150:151], v10 offset0:66 offset1:67
ds_read_b128 v[180:183], v14 offset:2816
v_mfma_f32_16x16x32_bf16 v[36:39], v[72:75], v[108:111], v[36:39]
v_mfma_f32_16x16x32_bf16 v[40:43], v[72:75], v[96:99], v[40:43]
v_mfma_f32_16x16x32_bf16 v[44:47], v[72:75], v[100:103], v[44:47]
v_mfma_f32_16x16x32_bf16 v[32:35], v[76:79], v[100:103], v[32:35]
v_mfma_f32_16x16x32_bf16 v[36:39], v[76:79], v[104:107], v[36:39]
v_mfma_f32_16x16x32_bf16 v[44:47], v[76:79], v[96:99], v[44:47]
v_mfma_f32_16x16x32_bf16 v[32:35], v[80:83], v[96:99], v[32:35]
v_mfma_f32_16x16x32_bf16 v[36:39], v[80:83], v[100:103], v[36:39]
v_mfma_f32_16x16x32_bf16 v[36:39], v[84:87], v[96:99], v[36:39]
s_waitcnt lgkmcnt(0)
v_mfma_f32_16x16x32_bf16 v[32:35], v[128:131], v[176:179], v[32:35]
ds_read2_b32 v[64:65], v8 offset0:176 offset1:177
ds_read2_b32 v[66:67], v8 offset0:178 offset1:179
v_mfma_f32_16x16x32_bf16 v[36:39], v[128:131], v[180:183], v[36:39]
ds_read_b128 v[96:99], v14 offset:192
ds_read2_b32 v[68:69], v8 offset0:48 offset1:49
v_mfma_f32_16x16x32_bf16 v[40:43], v[128:131], v[168:171], v[40:43]
ds_read2_b32 v[70:71], v8 offset0:50 offset1:51
ds_read_b128 v[100:103], v14 offset:704
v_mfma_f32_16x16x32_bf16 v[44:47], v[128:131], v[172:175], v[44:47]
ds_read2_b32 v[72:73], v9 offset0:176 offset1:177
ds_read2_b32 v[74:75], v9 offset0:178 offset1:179
v_mfma_f32_16x16x32_bf16 v[32:35], v[132:135], v[172:175], v[32:35]
ds_read_b128 v[104:107], v14 offset:1216
ds_read2_b32 v[76:77], v9 offset0:48 offset1:49
v_mfma_f32_16x16x32_bf16 v[36:39], v[132:135], v[176:179], v[36:39]
ds_read2_b32 v[78:79], v9 offset0:50 offset1:51
ds_read_b128 v[108:111], v14 offset:1728
v_mfma_f32_16x16x32_bf16 v[40:43], v[132:135], v[164:167], v[40:43]
ds_read2_b32 v[80:81], v10 offset0:176 offset1:177
ds_read2_b32 v[82:83], v10 offset0:178 offset1:179
v_mfma_f32_16x16x32_bf16 v[44:47], v[132:135], v[168:171], v[44:47]
ds_read_b128 v[112:115], v14 offset:2240
ds_read2_b32 v[84:85], v10 offset0:48 offset1:49
v_mfma_f32_16x16x32_bf16 v[32:35], v[136:139], v[168:171], v[32:35]
ds_read2_b32 v[86:87], v10 offset0:50 offset1:51
ds_read_b128 v[116:119], v14 offset:2752
v_mfma_f32_16x16x32_bf16 v[36:39], v[136:139], v[172:175], v[36:39]
v_mfma_f32_16x16x32_bf16 v[40:43], v[136:139], v[160:163], v[40:43]
v_mfma_f32_16x16x32_bf16 v[44:47], v[136:139], v[164:167], v[44:47]
v_mfma_f32_16x16x32_bf16 v[32:35], v[140:143], v[164:167], v[32:35]
v_mfma_f32_16x16x32_bf16 v[36:39], v[140:143], v[168:171], v[36:39]
v_mfma_f32_16x16x32_bf16 v[44:47], v[140:143], v[160:163], v[44:47]
v_mfma_f32_16x16x32_bf16 v[32:35], v[144:147], v[160:163], v[32:35]
v_mfma_f32_16x16x32_bf16 v[36:39], v[144:147], v[164:167], v[36:39]
v_mfma_f32_16x16x32_bf16 v[36:39], v[148:151], v[160:163], v[36:39]
s_waitcnt lgkmcnt(0)
v_mfma_f32_16x16x32_bf16 v[32:35], v[64:67], v[112:115], v[32:35]
ds_read2_b32 v[128:129], v8 offset0:160 offset1:161
ds_read2_b32 v[130:131], v8 offset0:162 offset1:163
v_mfma_f32_16x16x32_bf16 v[36:39], v[64:67], v[116:119], v[36:39]
ds_read_b128 v[160:163], v14 offset:128
ds_read2_b32 v[132:133], v8 offset0:32 offset1:33
v_mfma_f32_16x16x32_bf16 v[40:43], v[64:67], v[104:107], v[40:43]
ds_read2_b32 v[134:135], v8 offset0:34 offset1:35
ds_read_b128 v[164:167], v14 offset:640
v_mfma_f32_16x16x32_bf16 v[44:47], v[64:67], v[108:111], v[44:47]
ds_read2_b32 v[136:137], v9 offset0:160 offset1:161
ds_read2_b32 v[138:139], v9 offset0:162 offset1:163
v_mfma_f32_16x16x32_bf16 v[32:35], v[68:71], v[108:111], v[32:35]
ds_read_b128 v[168:171], v14 offset:1152
ds_read2_b32 v[140:141], v9 offset0:32 offset1:33
v_mfma_f32_16x16x32_bf16 v[36:39], v[68:71], v[112:115], v[36:39]
ds_read2_b32 v[142:143], v9 offset0:34 offset1:35
ds_read_b128 v[172:175], v14 offset:1664
v_mfma_f32_16x16x32_bf16 v[40:43], v[68:71], v[100:103], v[40:43]
ds_read2_b32 v[144:145], v10 offset0:160 offset1:161
ds_read2_b32 v[146:147], v10 offset0:162 offset1:163
v_mfma_f32_16x16x32_bf16 v[44:47], v[68:71], v[104:107], v[44:47]
ds_read_b128 v[176:179], v14 offset:2176
ds_read2_b32 v[148:149], v10 offset0:32 offset1:33
v_mfma_f32_16x16x32_bf16 v[32:35], v[72:75], v[104:107], v[32:35]
ds_read2_b32 v[150:151], v10 offset0:34 offset1:35
ds_read_b128 v[180:183], v14 offset:2688
v_mfma_f32_16x16x32_bf16 v[36:39], v[72:75], v[108:111], v[36:39]
v_mfma_f32_16x16x32_bf16 v[40:43], v[72:75], v[96:99], v[40:43]
v_mfma_f32_16x16x32_bf16 v[44:47], v[72:75], v[100:103], v[44:47]
v_mfma_f32_16x16x32_bf16 v[32:35], v[76:79], v[100:103], v[32:35]
v_mfma_f32_16x16x32_bf16 v[36:39], v[76:79], v[104:107], v[36:39]
v_mfma_f32_16x16x32_bf16 v[44:47], v[76:79], v[96:99], v[44:47]
v_mfma_f32_16x16x32_bf16 v[32:35], v[80:83], v[96:99], v[32:35]
v_mfma_f32_16x16x32_bf16 v[36:39], v[80:83], v[100:103], v[36:39]
v_mfma_f32_16x16x32_bf16 v[36:39], v[84:87], v[96:99], v[36:39]
s_waitcnt lgkmcnt(0)
v_mfma_f32_16x16x32_bf16 v[32:35], v[128:131], v[176:179], v[32:35]
ds_read2_b32 v[64:65], v8 offset0:144 offset1:145
ds_read2_b32 v[66:67], v8 offset0:146 offset1:147
v_mfma_f32_16x16x32_bf16 v[36:39], v[128:131], v[180:183], v[36:39]
ds_read_b128 v[96:99], v14 offset:64
ds_read2_b32 v[68:69], v8 offset0:16 offset1:17
v_mfma_f32_16x16x32_bf16 v[40:43], v[128:131], v[168:171], v[40:43]
ds_read2_b32 v[70:71], v8 offset0:18 offset1:19
ds_read_b128 v[100:103], v14 offset:576
v_mfma_f32_16x16x32_bf16 v[44:47], v[128:131], v[172:175], v[44:47]
ds_read2_b32 v[72:73], v9 offset0:144 offset1:145
ds_read2_b32 v[74:75], v9 offset0:146 offset1:147
v_mfma_f32_16x16x32_bf16 v[32:35], v[132:135], v[172:175], v[32:35]
ds_read_b128 v[104:107], v14 offset:1088
ds_read2_b32 v[76:77], v9 offset0:16 offset1:17
v_mfma_f32_16x16x32_bf16 v[36:39], v[132:135], v[176:179], v[36:39]
ds_read2_b32 v[78:79], v9 offset0:18 offset1:19
ds_read_b128 v[108:111], v14 offset:1600
v_mfma_f32_16x16x32_bf16 v[40:43], v[132:135], v[164:167], v[40:43]
ds_read2_b32 v[80:81], v10 offset0:144 offset1:145
ds_read2_b32 v[82:83], v10 offset0:146 offset1:147
v_mfma_f32_16x16x32_bf16 v[44:47], v[132:135], v[168:171], v[44:47]
ds_read_b128 v[112:115], v14 offset:2112
ds_read2_b32 v[84:85], v10 offset0:16 offset1:17
v_mfma_f32_16x16x32_bf16 v[32:35], v[136:139], v[168:171], v[32:35]
ds_read2_b32 v[86:87], v10 offset0:18 offset1:19
ds_read_b128 v[116:119], v14 offset:2624
v_mfma_f32_16x16x32_bf16 v[36:39], v[136:139], v[172:175], v[36:39]
v_mfma_f32_16x16x32_bf16 v[40:43], v[136:139], v[160:163], v[40:43]
v_mfma_f32_16x16x32_bf16 v[44:47], v[136:139], v[164:167], v[44:47]
v_mfma_f32_16x16x32_bf16 v[32:35], v[140:143], v[164:167], v[32:35]
v_mfma_f32_16x16x32_bf16 v[36:39], v[140:143], v[168:171], v[36:39]
v_mfma_f32_16x16x32_bf16 v[44:47], v[140:143], v[160:163], v[44:47]
v_mfma_f32_16x16x32_bf16 v[32:35], v[144:147], v[160:163], v[32:35]
v_mfma_f32_16x16x32_bf16 v[36:39], v[144:147], v[164:167], v[36:39]
v_mfma_f32_16x16x32_bf16 v[36:39], v[148:151], v[160:163], v[36:39]
s_waitcnt lgkmcnt(0)
v_mfma_f32_16x16x32_bf16 v[32:35], v[64:67], v[112:115], v[32:35]
ds_read2_b32 v[128:129], v8 offset0:128 offset1:129
ds_read2_b32 v[130:131], v8 offset0:130 offset1:131
v_mfma_f32_16x16x32_bf16 v[36:39], v[64:67], v[116:119], v[36:39]
ds_read_b128 v[160:163], v14 offset:0
ds_read2_b32 v[132:133], v8 offset0:0 offset1:1
v_mfma_f32_16x16x32_bf16 v[40:43], v[64:67], v[104:107], v[40:43]
ds_read2_b32 v[134:135], v8 offset0:2 offset1:3
ds_read_b128 v[164:167], v14 offset:512
v_mfma_f32_16x16x32_bf16 v[44:47], v[64:67], v[108:111], v[44:47]
ds_read2_b32 v[136:137], v9 offset0:128 offset1:129
ds_read2_b32 v[138:139], v9 offset0:130 offset1:131
v_mfma_f32_16x16x32_bf16 v[32:35], v[68:71], v[108:111], v[32:35]
ds_read_b128 v[168:171], v14 offset:1024
ds_read2_b32 v[140:141], v9 offset0:0 offset1:1
v_mfma_f32_16x16x32_bf16 v[36:39], v[68:71], v[112:115], v[36:39]
ds_read2_b32 v[142:143], v9 offset0:2 offset1:3
ds_read_b128 v[172:175], v14 offset:1536
v_mfma_f32_16x16x32_bf16 v[40:43], v[68:71], v[100:103], v[40:43]
ds_read2_b32 v[144:145], v10 offset0:128 offset1:129
ds_read2_b32 v[146:147], v10 offset0:130 offset1:131
v_mfma_f32_16x16x32_bf16 v[44:47], v[68:71], v[104:107], v[44:47]
ds_read_b128 v[176:179], v14 offset:2048
ds_read2_b32 v[148:149], v10 offset0:0 offset1:1
v_mfma_f32_16x16x32_bf16 v[32:35], v[72:75], v[104:107], v[32:35]
ds_read2_b32 v[150:151], v10 offset0:2 offset1:3
ds_read_b128 v[180:183], v14 offset:2560
v_mfma_f32_16x16x32_bf16 v[36:39], v[72:75], v[108:111], v[36:39]
v_mfma_f32_16x16x32_bf16 v[40:43], v[72:75], v[96:99], v[40:43]
v_mfma_f32_16x16x32_bf16 v[44:47], v[72:75], v[100:103], v[44:47]
v_mfma_f32_16x16x32_bf16 v[32:35], v[76:79], v[100:103], v[32:35]
v_mfma_f32_16x16x32_bf16 v[36:39], v[76:79], v[104:107], v[36:39]
v_mfma_f32_16x16x32_bf16 v[44:47], v[76:79], v[96:99], v[44:47]
v_mfma_f32_16x16x32_bf16 v[32:35], v[80:83], v[96:99], v[32:35]
v_mfma_f32_16x16x32_bf16 v[36:39], v[80:83], v[100:103], v[36:39]
v_mfma_f32_16x16x32_bf16 v[36:39], v[84:87], v[96:99], v[36:39]
s_waitcnt lgkmcnt(0)
v_mfma_f32_16x16x32_bf16 v[32:35], v[128:131], v[176:179], v[32:35]
ds_read_b64 v[48:49], v15 offset:2048
ds_read_b64 v[50:51], v15 offset:2560
v_mfma_f32_16x16x32_bf16 v[36:39], v[128:131], v[180:183], v[36:39]
ds_read_b64 v[52:53], v15 offset:1024
ds_read_b64 v[54:55], v15 offset:1536
v_mfma_f32_16x16x32_bf16 v[40:43], v[128:131], v[168:171], v[40:43]
v_mfma_f32_16x16x32_bf16 v[44:47], v[128:131], v[172:175], v[44:47]
v_mfma_f32_16x16x32_bf16 v[32:35], v[132:135], v[172:175], v[32:35]
v_mfma_f32_16x16x32_bf16 v[36:39], v[132:135], v[176:179], v[36:39]
v_mfma_f32_16x16x32_bf16 v[40:43], v[132:135], v[164:167], v[40:43]
v_mfma_f32_16x16x32_bf16 v[44:47], v[132:135], v[168:171], v[44:47]
v_mfma_f32_16x16x32_bf16 v[32:35], v[136:139], v[168:171], v[32:35]
v_mfma_f32_16x16x32_bf16 v[36:39], v[136:139], v[172:175], v[36:39]
v_mfma_f32_16x16x32_bf16 v[40:43], v[136:139], v[160:163], v[40:43]
v_mfma_f32_16x16x32_bf16 v[44:47], v[136:139], v[164:167], v[44:47]
v_mfma_f32_16x16x32_bf16 v[32:35], v[140:143], v[164:167], v[32:35]
v_mfma_f32_16x16x32_bf16 v[36:39], v[140:143], v[168:171], v[36:39]
v_mfma_f32_16x16x32_bf16 v[44:47], v[140:143], v[160:163], v[44:47]
v_mfma_f32_16x16x32_bf16 v[32:35], v[144:147], v[160:163], v[32:35]
v_mfma_f32_16x16x32_bf16 v[36:39], v[144:147], v[164:167], v[36:39]
v_mfma_f32_16x16x32_bf16 v[36:39], v[148:151], v[160:163], v[36:39]
v_add_u32 v18, 2048, v17
v_add_u32 v17, 1024, v17
L_B_conv2:
s_nop 7
s_waitcnt lgkmcnt(0)
v_cvt_pk_bf16_f32 v80, v32, v33
v_lshlrev_b32 v81, 16, v48
v_and_b32 v82, 0xffff0000, v48
v_mul_f32 v81, v81, v27
v_mul_f32 v82, v82, v27
v_cvt_pk_bf16_f32 v81, v81, v82
v_lshlrev_b32 v82, 16, v80
v_and_b32 v80, 0xffff0000, v80
v_lshlrev_b32 v83, 16, v81
v_and_b32 v81, 0xffff0000, v81
v_add_f32 v82, v82, v83
v_add_f32 v80, v80, v81
v_cvt_pk_bf16_f32 v64, v82, v80
v_cvt_pk_bf16_f32 v84, v34, v35
v_lshlrev_b32 v85, 16, v49
v_and_b32 v86, 0xffff0000, v49
v_mul_f32 v85, v85, v27
v_mul_f32 v86, v86, v27
v_cvt_pk_bf16_f32 v85, v85, v86
v_lshlrev_b32 v86, 16, v84
v_and_b32 v84, 0xffff0000, v84
v_lshlrev_b32 v87, 16, v85
v_and_b32 v85, 0xffff0000, v85
v_add_f32 v86, v86, v87
v_add_f32 v84, v84, v85
v_cvt_pk_bf16_f32 v65, v86, v84
ds_write_b64 v18, v[64:65] offset:0
v_cvt_pk_bf16_f32 v80, v36, v37
v_lshlrev_b32 v81, 16, v50
v_and_b32 v82, 0xffff0000, v50
v_mul_f32 v81, v81, v27
v_mul_f32 v82, v82, v27
v_cvt_pk_bf16_f32 v81, v81, v82
v_lshlrev_b32 v82, 16, v80
v_and_b32 v80, 0xffff0000, v80
v_lshlrev_b32 v83, 16, v81
v_and_b32 v81, 0xffff0000, v81
v_add_f32 v82, v82, v83
v_add_f32 v80, v80, v81
v_cvt_pk_bf16_f32 v66, v82, v80
v_cvt_pk_bf16_f32 v84, v38, v39
v_lshlrev_b32 v85, 16, v51
v_and_b32 v86, 0xffff0000, v51
v_mul_f32 v85, v85, v27
v_mul_f32 v86, v86, v27
v_cvt_pk_bf16_f32 v85, v85, v86
v_lshlrev_b32 v86, 16, v84
v_and_b32 v84, 0xffff0000, v84
v_lshlrev_b32 v87, 16, v85
v_and_b32 v85, 0xffff0000, v85
v_add_f32 v86, v86, v87
v_add_f32 v84, v84, v85
v_cvt_pk_bf16_f32 v67, v86, v84
ds_write_b64 v18, v[66:67] offset:512
v_cvt_pk_bf16_f32 v80, v40, v41
v_lshlrev_b32 v81, 16, v52
v_and_b32 v82, 0xffff0000, v52
v_mul_f32 v81, v81, v27
v_mul_f32 v82, v82, v27
v_cvt_pk_bf16_f32 v81, v81, v82
v_lshlrev_b32 v82, 16, v80
v_and_b32 v80, 0xffff0000, v80
v_lshlrev_b32 v83, 16, v81
v_and_b32 v81, 0xffff0000, v81
v_add_f32 v82, v82, v83
v_add_f32 v80, v80, v81
v_cvt_pk_bf16_f32 v68, v82, v80
v_cvt_pk_bf16_f32 v84, v42, v43
v_lshlrev_b32 v85, 16, v53
v_and_b32 v86, 0xffff0000, v53
v_mul_f32 v85, v85, v27
v_mul_f32 v86, v86, v27
v_cvt_pk_bf16_f32 v85, v85, v86
v_lshlrev_b32 v86, 16, v84
v_and_b32 v84, 0xffff0000, v84
v_lshlrev_b32 v87, 16, v85
v_and_b32 v85, 0xffff0000, v85
v_add_f32 v86, v86, v87
v_add_f32 v84, v84, v85
v_cvt_pk_bf16_f32 v69, v86, v84
ds_write_b64 v17, v[68:69] offset:0
v_cvt_pk_bf16_f32 v80, v44, v45
v_lshlrev_b32 v81, 16, v54
v_and_b32 v82, 0xffff0000, v54
v_mul_f32 v81, v81, v27
v_mul_f32 v82, v82, v27
v_cvt_pk_bf16_f32 v81, v81, v82
v_lshlrev_b32 v82, 16, v80
v_and_b32 v80, 0xffff0000, v80
v_lshlrev_b32 v83, 16, v81
v_and_b32 v81, 0xffff0000, v81
v_add_f32 v82, v82, v83
v_add_f32 v80, v80, v81
v_cvt_pk_bf16_f32 v70, v82, v80
v_cvt_pk_bf16_f32 v84, v46, v47
v_lshlrev_b32 v85, 16, v55
v_and_b32 v86, 0xffff0000, v55
v_mul_f32 v85, v85, v27
v_mul_f32 v86, v86, v27
v_cvt_pk_bf16_f32 v85, v85, v86
v_lshlrev_b32 v86, 16, v84
v_and_b32 v84, 0xffff0000, v84
v_lshlrev_b32 v87, 16, v85
v_and_b32 v85, 0xffff0000, v85
v_add_f32 v86, v86, v87
v_add_f32 v84, v84, v85
v_cvt_pk_bf16_f32 v71, v86, v84
ds_write_b64 v17, v[70:71] offset:512
v_lshlrev_b32 v12, 3, v7
v_add_u32 v12, 113280, v12
v_lshlrev_b32 v13, 14, v7
s_lshl_b32 s82, s51, 2
s_add_u32 s82, s82, 2048
s_waitcnt lgkmcnt(0)
s_barrier
ds_read_b64 v[96:97], v12 offset:0
ds_read_b64 v[98:99], v12 offset:4096
ds_read_b64 v[100:101], v12 offset:8192
ds_read_b64 v[102:103], v12 offset:12288
s_waitcnt lgkmcnt(0)
v_lshlrev_b32 v112, 16, v96
v_lshlrev_b32 v113, 16, v98
v_lshlrev_b32 v114, 16, v100
v_lshlrev_b32 v115, 16, v102
buffer_store_dwordx4 v[112:115], v13, s[72:75], s82 offen
s_add_u32 s82, s82, 4096
v_and_b32 v116, 0xffff0000, v96
v_and_b32 v117, 0xffff0000, v98
v_and_b32 v118, 0xffff0000, v100
v_and_b32 v119, 0xffff0000, v102
buffer_store_dwordx4 v[116:119], v13, s[72:75], s82 offen
s_add_u32 s82, s82, 4096
v_lshlrev_b32 v120, 16, v97
v_lshlrev_b32 v121, 16, v99
v_lshlrev_b32 v122, 16, v101
v_lshlrev_b32 v123, 16, v103
buffer_store_dwordx4 v[120:123], v13, s[72:75], s82 offen
s_add_u32 s82, s82, 4096
v_and_b32 v124, 0xffff0000, v97
v_and_b32 v125, 0xffff0000, v99
v_and_b32 v126, 0xffff0000, v101
v_and_b32 v127, 0xffff0000, v103
buffer_store_dwordx4 v[124:127], v13, s[72:75], s82 offen
L_end:
s_endpgm
.fill (33024 - (. - concat_heads__ssm_conv_s5__ssm_conv_s4__prompt_kernel))/4, 4, 0xbf800000
.section .rodata,"a"
.p2align 6
.amdhsa_kernel concat_heads__ssm_conv_s5__ssm_conv_s4__prompt_kernel
  .amdhsa_next_free_vgpr 256
  .amdhsa_next_free_sgpr 102
  .amdhsa_accum_offset 256
  .amdhsa_group_segment_fixed_size 0
  .amdhsa_kernarg_size 168
  .amdhsa_user_sgpr_count 2
  .amdhsa_user_sgpr_kernarg_segment_ptr 1
  .amdhsa_system_sgpr_workgroup_id_x 1
.end_amdhsa_kernel
```
